```python
import torch

def _softmax(x, axis=-1):
    return torch.softmax(x, dim=axis)
def _gelu(x):
    return torch.nn.functional.gelu(x, approximate="tanh")
def _silu(x):
    return torch.nn.functional.silu(x)
def _sigmoid(x):
    return torch.sigmoid(x)
def _layernorm(x, axis=-1, eps=1e-5):
    m = x.mean(dim=axis, keepdim=True)
    v = x.var(dim=axis, keepdim=True, unbiased=False)
    return (x - m) / torch.sqrt(v + eps)
def _scatter_add(tgt, idx, src, axis=0):
    return tgt.clone().index_add_(axis, idx, src)
def _segment_sum(src, seg, n):
    out = torch.zeros((n,) + src.shape[1:], dtype=src.dtype)
    return out.index_add_(0, seg, src)
def _pad(x, pw):
    flat = tuple(v for pair in reversed(pw) for v in pair)
    return torch.nn.functional.pad(x, flat)

kernel_name = 'sequential_preLN__mha_block_cached__mixer_token_mlp__decode'

def setup_inputs():

    _w = (lambda a: (lambda t: t.to(torch.bfloat16) if t.is_floating_point() else t)(torch.as_tensor(a)))
    def _A_setup():
        B, Sq, D = 4, 1, 448
        H, Sk, Dh = 16, 4096, 256
        return {
            "x": _w((lambda *s: torch.randn(*s, dtype=torch.bfloat16) * 0.05)(B, Sq, D)),
            "k_cache": _w((lambda *s: torch.randn(*s, dtype=torch.bfloat16) * 1.6)(B, H, Sk, Dh)),
            "v_cache": _w((lambda *s: torch.randn(*s, dtype=torch.bfloat16) * 0.4)(B, H, Sk, Dh)),
            "wq": _w((lambda *s: torch.randn(*s, dtype=torch.bfloat16) * 1.6)(D, H * Dh) * (D ** -0.5)),
            "wo": _w((lambda *s: torch.randn(*s, dtype=torch.bfloat16) * 0.4)(H * Dh, D) * ((H * Dh) ** -0.5)),
        }
    _A_in = _A_setup()

    def _B_setup():
        B, S, D, F = 4, 1, 448, 1792
        return {
            "x": _w((lambda *s: torch.randn(*s, dtype=torch.bfloat16) * 0.05)(B, S, D)),
            "w1": _w((lambda *s: torch.randn(*s, dtype=torch.bfloat16) * 1.6)(S, F) * (S ** -0.5)),
            "b1": _w((lambda *s: torch.randn(*s, dtype=torch.bfloat16) * 0.1)(F) * 0.02),
            "w2": _w((lambda *s: torch.randn(*s, dtype=torch.bfloat16) * 0.1)(F, S) * (F ** -0.5)),
            "b2": _w((lambda *s: torch.randn(*s, dtype=torch.bfloat16) * 0.1)(S) * 0.02),
        }
    _B_in = _B_setup()

    return {
        "A_x": _A_in["x"],
        "A_k_cache": _A_in["k_cache"],
        "A_v_cache": _A_in["v_cache"],
        "A_wq": _A_in["wq"],
        "A_wo": _A_in["wo"],
        "B_x": _B_in["x"],
        "B_w1": _B_in["w1"],
        "B_b1": _B_in["b1"],
        "B_w2": _B_in["w2"],
        "B_b2": _B_in["b2"],
    }

def reference(A_x, A_k_cache, A_v_cache, A_wq, A_wo, B_x, B_w1, B_b1, B_w2, B_b2):
    def _A_ref(x, k_cache, v_cache, wq, wo):
        B, Sq, D = x.shape
        H, Dh = 16, 256
        q = (lambda x, *d: x.permute(*d))((x @ wq).reshape(B, Sq, H, Dh), 0, 2, 1, 3)
        scores = torch.einsum("bhqd,bhkd->bhqk", q, k_cache) * (Dh ** -0.5)
        p = _softmax(scores, axis=-1)
        o = torch.einsum("bhqk,bhkd->bhqd", p, v_cache)
        return (lambda x, *d: x.permute(*d))(o, 0, 2, 1, 3).reshape(B, Sq, H * Dh) @ wo

    def _B_ref(x, w1, b1, w2, b2):
        B, S, D = x.shape
        h = _layernorm(x, axis=-1)
        u = torch.einsum("bsd,sf->bdf", h, w1) + b1
        u = _gelu(u)
        y = torch.einsum("bdf,fs->bds", u, w2) + b2
        return (lambda x, *d: x.permute(*d))(y, 0, 2, 1)

    x = A_x
    h = x + _A_ref(_layernorm(x, axis=-1), A_k_cache, A_v_cache, A_wq, A_wo)
    h2 = h + _B_ref(_layernorm(h, axis=-1), B_w1, B_b1, B_w2, B_b2)
    return h2
```

```asm
; @launch grid=(256,1,1) block=(512,1,1) lds=99328
.amdgcn_target "amdgcn-amd-amdhsa--gfx950"
.text
.globl sequential_preLN__mha_block_cached__mixer_token_mlp__decode_kernel
.p2align 8
.type sequential_preLN__mha_block_cached__mixer_token_mlp__decode_kernel,@function
sequential_preLN__mha_block_cached__mixer_token_mlp__decode_kernel:
  s_cmp_ge_u32 s2, 256
  s_cbranch_scc1 L_exit
  s_memrealtime s[98:99]
  s_load_dwordx16 s[8:23], s[0:1], 0
  s_load_dwordx8 s[24:31], s[0:1], 64
  s_load_dwordx2 s[32:33], s[0:1], 96
  v_lshrrev_b32 v1, 6, v0
  s_lshr_b32 s7, s2, 3
  v_readfirstlane_b32 s3, v1
  s_bfe_u32 s4, s2, 0x10001
  s_lshl1_add_u32 s4, s7, s4
  s_bfe_u32 s6, s2, 0x10002
  s_and_b32 s5, s2, 1
  s_lshl1_add_u32 s5, s6, s5
  s_xor_b32 s7, s7, s5
  s_and_b32 s7, s7, 3
  s_cmp_eq_u32 s7, 0
  s_cselect_b32 s5, 1, 0
  s_cmp_ge_u32 s3, 4
  s_cbranch_scc1 L_helper
  v_lshlrev_b32 v2, 4, v0
  v_add_u32 v3, 4096, v2
  v_add_u32 v4, 8192, v2
  v_add_u32 v5, 12288, v2
  v_add_u32 v6, 16384, v2
  v_add_u32 v7, 20480, v2
  v_add_u32 v8, 24576, v2
  v_add_u32 v9, 28672, v2
  s_lshl_b32 s7, s4, 21
  s_mov_b32 s38, 0x200000
  s_mov_b32 s39, 0x20000
  s_mov_b32 s42, 0x200000
  s_mov_b32 s43, 0x20000
  s_bfe_u32 s45, s2, 0x10002
  s_and_b32 s44, s2, 1
  s_lshl1_add_u32 s44, s45, s44
  s_mul_i32 s44, s44, 32768
  s_or_b32 s47, s2, s3
  v_lshlrev_b32 v11, 6, v0
  s_waitcnt lgkmcnt(0)
  s_cmp_lg_u32 s47, 0
  s_cbranch_scc1 L_sn0
  s_and_b32 s49, s98, 0x3fff
  s_lshl_b32 s48, s98, 2
  s_and_b32 s48, s48, 0x3fff0000
  s_or_b32 s48, s48, s49
  s_or_b32 s48, s48, 0x8000
  v_mov_b32 v10, s48
  s_mov_b64 exec, 15
  global_store_dword v11, v10, s[30:31] sc1
  s_mov_b64 exec, -1
L_sn0:
  s_add_u32 s36, s10, s7
  s_addc_u32 s37, s11, 0
  s_add_u32 s40, s12, s7
  s_addc_u32 s41, s13, 0
  s_cmp_eq_u32 s5, 0
  s_cbranch_scc1 L_spd
  s_barrier
L_spd:
  buffer_load_dwordx4 v[112:115], v2, s[36:39], s44 offen nt
  buffer_load_dwordx4 v[116:119], v3, s[36:39], s44 offen nt
  buffer_load_dwordx4 v[120:123], v4, s[36:39], s44 offen nt
  buffer_load_dwordx4 v[124:127], v5, s[36:39], s44 offen nt
  buffer_load_dwordx4 v[128:131], v6, s[36:39], s44 offen nt
  buffer_load_dwordx4 v[132:135], v7, s[36:39], s44 offen nt
  buffer_load_dwordx4 v[136:139], v8, s[36:39], s44 offen nt
  buffer_load_dwordx4 v[140:143], v9, s[36:39], s44 offen nt
  buffer_load_dwordx4 v[144:147], v2, s[40:43], s44 offen nt
  buffer_load_dwordx4 v[148:151], v3, s[40:43], s44 offen nt
  buffer_load_dwordx4 v[152:155], v4, s[40:43], s44 offen nt
  buffer_load_dwordx4 v[156:159], v5, s[40:43], s44 offen nt
  s_waitcnt vmcnt(11)
  buffer_load_dwordx4 v[160:163], v6, s[40:43], s44 offen nt
  s_waitcnt vmcnt(11)
  buffer_load_dwordx4 v[164:167], v7, s[40:43], s44 offen nt
  s_waitcnt vmcnt(11)
  buffer_load_dwordx4 v[168:171], v8, s[40:43], s44 offen nt
  s_waitcnt vmcnt(11)
  buffer_load_dwordx4 v[172:175], v9, s[40:43], s44 offen nt
  s_add_u32 s44, s44, 0x20000
  s_waitcnt vmcnt(11)
  buffer_load_dwordx4 v[176:179], v2, s[36:39], s44 offen nt
  s_waitcnt vmcnt(11)
  buffer_load_dwordx4 v[180:183], v3, s[36:39], s44 offen nt
  s_waitcnt vmcnt(11)
  buffer_load_dwordx4 v[184:187], v4, s[36:39], s44 offen nt
  s_waitcnt vmcnt(11)
  buffer_load_dwordx4 v[188:191], v5, s[36:39], s44 offen nt
  s_waitcnt vmcnt(11)
  buffer_load_dwordx4 v[192:195], v6, s[36:39], s44 offen nt
  s_waitcnt vmcnt(11)
  buffer_load_dwordx4 v[196:199], v7, s[36:39], s44 offen nt
  s_waitcnt vmcnt(11)
  buffer_load_dwordx4 v[200:203], v8, s[36:39], s44 offen nt
  s_waitcnt vmcnt(11)
  buffer_load_dwordx4 v[204:207], v9, s[36:39], s44 offen nt
  s_waitcnt vmcnt(11)
  buffer_load_dwordx4 v[208:211], v2, s[40:43], s44 offen nt
  s_waitcnt vmcnt(11)
  buffer_load_dwordx4 v[212:215], v3, s[40:43], s44 offen nt
  s_waitcnt vmcnt(11)
  buffer_load_dwordx4 v[216:219], v4, s[40:43], s44 offen nt
  s_waitcnt vmcnt(11)
  buffer_load_dwordx4 v[220:223], v5, s[40:43], s44 offen nt
  s_waitcnt vmcnt(11)
  buffer_load_dwordx4 v[224:227], v6, s[40:43], s44 offen nt
  s_waitcnt vmcnt(11)
  buffer_load_dwordx4 v[228:231], v7, s[40:43], s44 offen nt
  s_waitcnt vmcnt(11)
  buffer_load_dwordx4 v[232:235], v8, s[40:43], s44 offen nt
  s_waitcnt vmcnt(11)
  buffer_load_dwordx4 v[236:239], v9, s[40:43], s44 offen nt
  s_add_u32 s44, s44, 0x20000
  s_load_dword s6, s[30:31], 192
  s_waitcnt vmcnt(11)
  buffer_load_dwordx4 v[48:51], v2, s[36:39], s44 offen nt
  s_waitcnt vmcnt(11)
  buffer_load_dwordx4 v[52:55], v3, s[36:39], s44 offen nt
  s_waitcnt vmcnt(11)
  buffer_load_dwordx4 v[56:59], v4, s[36:39], s44 offen nt
  s_waitcnt vmcnt(11)
  buffer_load_dwordx4 v[60:63], v5, s[36:39], s44 offen nt
  s_waitcnt vmcnt(11)
  buffer_load_dwordx4 v[64:67], v6, s[36:39], s44 offen nt
  s_waitcnt vmcnt(11)
  buffer_load_dwordx4 v[68:71], v7, s[36:39], s44 offen nt
  s_waitcnt vmcnt(11)
  buffer_load_dwordx4 v[72:75], v8, s[36:39], s44 offen nt
  s_waitcnt vmcnt(11)
  buffer_load_dwordx4 v[76:79], v9, s[36:39], s44 offen nt
  s_waitcnt vmcnt(11)
  buffer_load_dwordx4 v[80:83], v2, s[40:43], s44 offen nt
  s_waitcnt vmcnt(11)
  buffer_load_dwordx4 v[84:87], v3, s[40:43], s44 offen nt
  s_waitcnt vmcnt(11)
  buffer_load_dwordx4 v[88:91], v4, s[40:43], s44 offen nt
  s_waitcnt vmcnt(11)
  buffer_load_dwordx4 v[92:95], v5, s[40:43], s44 offen nt
  s_mov_b32 s47, s44
  s_lshl_b32 s48, s4, 8
  s_add_u32 s48, s48, 344064
  s_add_u32 s52, s32, s48
  s_addc_u32 s53, s33, 0
  s_lshl_b32 s54, s3, 10
  s_sub_u32 s54, 1703936, s54
  s_setprio 2
  v_mov_b32 v14, 0
  v_mov_b32 v15, 0
  v_mov_b32 v16, 0
  v_mov_b32 v17, 0
  v_mov_b32 v18, 0
  v_mov_b32 v19, 0
  v_mov_b32 v20, 0
  v_mov_b32 v21, 0
  v_mov_b32 v40, 0xff800000
  v_mov_b32 v41, 0
  s_mov_b32 s46, 0x3db8aa3b
  s_mov_b32 s45, 11
  s_mov_b64 s[56:57], 0
  s_mov_b32 s62, 0
  v_mov_b32 v254, 0xff800000
  v_mov_b32 v255, 0
  v_and_b32 v253, 63, v0
  v_cmp_le_u32 vcc, 24, v253
  v_and_b32 v45, 31, v0
  v_lshlrev_b32 v247, 4, v45
  v_cndmask_b32 v30, 0, 24, vcc
  v_sub_u32 v30, v253, v30
  v_mul_u32_u24 v249, 24, v30
  v_cndmask_b32 v31, 0, 1, vcc
  v_lshl_add_u32 v249, v31, 9, v249
  v_cmp_eq_u32 s[58:59], 21, v30
  v_cmp_gt_u32 s[60:61], 21, v30
  v_cmp_gt_u32 s[64:65], 22, v30
  v_lshlrev_b32 v46, 5, v45
  v_bfe_u32 v30, v0, 5, 1
  v_lshl_add_u32 v46, v30, 4, v46
  s_lshl_b32 s7, s3, 10
  v_add_u32 v46, s7, v46
  s_lshl_b32 s7, s3, 3
  v_mov_b32 v45, s7
  s_and_b32 s48, s4, 15
  s_lshr_b32 s66, s48, 3
  s_lshl_b32 s66, s66, 13
  s_lshl_b32 s48, s48, 15
  s_add_u32 s48, s48, s66
  s_lshr_b32 s67, s4, 4
  s_bfe_u32 s7, s2, 0x10002
  s_and_b32 s49, s2, 1
  s_lshl1_add_u32 s49, s7, s49
  s_lshl2_add_u32 s49, s67, s49
  s_mul_i32 s49, s49, 384
  s_add_u32 s48, s48, s49
  s_add_u32 s48, s48, 1048576
  v_lshl_add_u32 v248, v253, 4, s48
  v_mul_u32_u24 v31, 16000, v31
  v_add_u32 v248, v248, v31
  v_mov_b32 v30, 0
  s_waitcnt lgkmcnt(0)
  s_and_b32 s48, s6, 0x3fff
  s_lshr_b32 s49, s6, 2
  s_and_b32 s49, s49, 0x0fffc000
  s_or_b32 s48, s48, s49
  s_sub_u32 s48, s48, s98
  s_add_u32 s48, s48, 1500
  s_bfe_u32 s48, s48, 0x1001b
  s_bfe_u32 s49, s6, 0x1000f
  s_cmp_gt_u32 s49, s48
  s_cbranch_scc0 L_snw
L_snok:
  s_mov_b32 s48, 262144
  v_mov_b32 v47, s6
  s_branch L_sqw
L_sqs:
  s_sleep 1
L_sqw:
  ds_read_b128 v[32:35], v30 offset:576
  ds_read_b128 v[10:13], v247 offset:64
  s_sub_u32 s48, s48, 1
  s_cbranch_scc1 L_exit
  s_waitcnt lgkmcnt(0)
  v_xor_b32 v32, s6, v32
  v_bitop3_b32 v32, v33, s6, v32 bitop3:0xbe
  v_bitop3_b32 v32, v34, s6, v32 bitop3:0xbe
  v_bitop3_b32 v32, v35, s6, v32 bitop3:0xbe
  v_cmp_eq_u32 vcc, 0, v32
  s_cbranch_vccz L_sqs
L_sloop:
  s_waitcnt vmcnt(11)
  v_dot2_f32_bf16 v22, v48, v10, 0
  v_dot2_f32_bf16 v22, v49, v11, v22
  v_dot2_f32_bf16 v22, v50, v12, v22
  v_dot2_f32_bf16 v22, v51, v13, v22
  buffer_load_dwordx4 v[96:99], v6, s[40:43], s47 offen nt
  s_waitcnt vmcnt(11)
  v_dot2_f32_bf16 v23, v52, v10, 0
  v_dot2_f32_bf16 v23, v53, v11, v23
  v_dot2_f32_bf16 v23, v54, v12, v23
  v_dot2_f32_bf16 v23, v55, v13, v23
  buffer_load_dwordx4 v[100:103], v7, s[40:43], s47 offen nt
  s_waitcnt vmcnt(11)
  v_dot2_f32_bf16 v24, v56, v10, 0
  v_dot2_f32_bf16 v24, v57, v11, v24
  v_dot2_f32_bf16 v24, v58, v12, v24
  v_dot2_f32_bf16 v24, v59, v13, v24
  buffer_load_dwordx4 v[104:107], v8, s[40:43], s47 offen nt
  s_waitcnt vmcnt(11)
  v_dot2_f32_bf16 v25, v60, v10, 0
  v_dot2_f32_bf16 v25, v61, v11, v25
  v_dot2_f32_bf16 v25, v62, v12, v25
  v_dot2_f32_bf16 v25, v63, v13, v25
  buffer_load_dwordx4 v[108:111], v9, s[40:43], s47 offen nt
  s_waitcnt vmcnt(11)
  v_dot2_f32_bf16 v26, v64, v10, 0
  v_dot2_f32_bf16 v26, v65, v11, v26
  v_dot2_f32_bf16 v26, v66, v12, v26
  v_dot2_f32_bf16 v26, v67, v13, v26
  s_add_u32 s44, s47, 0x20000
  s_cmp_gt_u32 s45, 1
  s_cbranch_scc1 L_st1
  s_waitcnt lgkmcnt(0)
  s_cmp_lg_u32 s51, s6
  s_cbranch_scc1 L_tkretry
L_tkok:
  s_lshr_b32 s48, s50, 2
  s_lshl_b32 s48, s48, 15
  s_and_b32 s49, s50, 3
  s_lshl_b32 s49, s49, 10
  s_add_u32 s48, s48, s49
  s_add_u32 s48, s48, s54
  s_cmp_lt_u32 s50, 48
  s_cselect_b32 s44, s48, 0x200000
L_st1:
  buffer_load_dwordx4 v[48:51], v2, s[36:39], s44 offen nt
  s_waitcnt vmcnt(11)
  v_dot2_f32_bf16 v27, v68, v10, 0
  v_dot2_f32_bf16 v27, v69, v11, v27
  v_dot2_f32_bf16 v27, v70, v12, v27
  v_dot2_f32_bf16 v27, v71, v13, v27
  buffer_load_dwordx4 v[52:55], v3, s[36:39], s44 offen nt
  s_waitcnt vmcnt(11)
  v_dot2_f32_bf16 v28, v72, v10, 0
  v_dot2_f32_bf16 v28, v73, v11, v28
  v_dot2_f32_bf16 v28, v74, v12, v28
  v_dot2_f32_bf16 v28, v75, v13, v28
  buffer_load_dwordx4 v[56:59], v4, s[36:39], s44 offen nt
  s_waitcnt vmcnt(11)
  v_dot2_f32_bf16 v29, v76, v10, 0
  v_dot2_f32_bf16 v29, v77, v11, v29
  v_dot2_f32_bf16 v29, v78, v12, v29
  v_dot2_f32_bf16 v29, v79, v13, v29
  buffer_load_dwordx4 v[60:63], v5, s[36:39], s44 offen nt
  v_add_f32_dpp v22, v22, v22 row_ror:8 row_mask:0xf bank_mask:0x3
  v_add_f32_dpp v22, v23, v23 row_ror:8 row_mask:0xf bank_mask:0xc
  v_add_f32_dpp v24, v24, v24 row_ror:8 row_mask:0xf bank_mask:0x3
  v_add_f32_dpp v24, v25, v25 row_ror:8 row_mask:0xf bank_mask:0xc
  v_add_f32_dpp v26, v26, v26 row_ror:8 row_mask:0xf bank_mask:0x3
  v_add_f32_dpp v26, v27, v27 row_ror:8 row_mask:0xf bank_mask:0xc
  v_add_f32_dpp v28, v28, v28 row_ror:8 row_mask:0xf bank_mask:0x3
  v_add_f32_dpp v28, v29, v29 row_ror:8 row_mask:0xf bank_mask:0xc
  v_add_f32_dpp v22, v22, v22 row_half_mirror row_mask:0xf bank_mask:0x5
  v_add_f32_dpp v22, v24, v24 row_half_mirror row_mask:0xf bank_mask:0xa
  v_add_f32_dpp v26, v26, v26 row_half_mirror row_mask:0xf bank_mask:0x5
  v_add_f32_dpp v26, v28, v28 row_half_mirror row_mask:0xf bank_mask:0xa
  s_nop 1
  v_permlane16_swap_b32 v22, v26
  v_add_f32 v22, v22, v26
  s_nop 1
  v_add_f32_dpp v22, v22, v22 quad_perm:[1,0,3,2] row_mask:0xf bank_mask:0xf
  s_nop 1
  v_add_f32_dpp v22, v22, v22 quad_perm:[2,3,0,1] row_mask:0xf bank_mask:0xf
  v_cvt_pk_bf16_f32 v30, 0, v22
  s_nop 1
  v_max_f32_dpp v31, v30, v30 row_ror:8 row_mask:0xf bank_mask:0xf
  s_nop 1
  v_max_f32_dpp v31, v31, v31 row_half_mirror row_mask:0xf bank_mask:0xf
  v_mov_b32 v32, v31
  s_nop 1
  v_permlane16_swap_b32 v31, v32
  v_max_f32 v31, v31, v32
  v_mov_b32 v32, v31
  s_nop 1
  v_permlane32_swap_b32 v31, v32
  v_max_f32 v31, v31, v32
  v_mul_f32 v31, s46, v31
  v_max_f32 v33, v40, v31
  v_fma_f32 v35, v30, s46, -v33
  v_sub_f32 v34, v40, v33
  v_exp_f32 v35, v35
  v_exp_f32 v34, v34
  v_mov_b32 v40, v33
  v_mov_b32 v36, v35
  v_mul_f32 v14, v14, v34
  v_mul_f32 v15, v15, v34
  v_permlane16_swap_b32 v35, v36
  v_mul_f32 v16, v16, v34
  v_mul_f32 v17, v17, v34
  v_mul_f32 v18, v18, v34
  v_mul_f32 v19, v19, v34
  v_mul_f32 v20, v20, v34
  v_mul_f32 v21, v21, v34
  v_cvt_pk_bf16_f32 v37, v35, 0
  v_cvt_pk_bf16_f32 v38, 0, v35
  v_cvt_pk_bf16_f32 v39, v36, 0
  v_cvt_pk_bf16_f32 v42, 0, v36
  v_add_f32 v43, v35, v36
  v_mul_f32 v41, v41, v34
  s_waitcnt vmcnt(11)
  v_dot2c_f32_bf16_dpp v14, v37, v80 row_newbcast:0 row_mask:0xf bank_mask:0xf
  v_dot2c_f32_bf16_dpp v15, v38, v80 row_newbcast:0 row_mask:0xf bank_mask:0xf
  v_dot2c_f32_bf16_dpp v16, v37, v81 row_newbcast:0 row_mask:0xf bank_mask:0xf
  v_dot2c_f32_bf16_dpp v17, v38, v81 row_newbcast:0 row_mask:0xf bank_mask:0xf
  v_dot2c_f32_bf16_dpp v18, v37, v82 row_newbcast:0 row_mask:0xf bank_mask:0xf
  v_dot2c_f32_bf16_dpp v19, v38, v82 row_newbcast:0 row_mask:0xf bank_mask:0xf
  v_dot2c_f32_bf16_dpp v20, v37, v83 row_newbcast:0 row_mask:0xf bank_mask:0xf
  v_dot2c_f32_bf16_dpp v21, v38, v83 row_newbcast:0 row_mask:0xf bank_mask:0xf
  buffer_load_dwordx4 v[64:67], v6, s[36:39], s44 offen nt
  v_add_f32_dpp v43, v43, v43 row_ror:8 row_mask:0xf bank_mask:0xf
  s_waitcnt vmcnt(11)
  v_dot2c_f32_bf16_dpp v14, v37, v84 row_newbcast:8 row_mask:0xf bank_mask:0xf
  v_dot2c_f32_bf16_dpp v15, v38, v84 row_newbcast:8 row_mask:0xf bank_mask:0xf
  v_dot2c_f32_bf16_dpp v16, v37, v85 row_newbcast:8 row_mask:0xf bank_mask:0xf
  v_dot2c_f32_bf16_dpp v17, v38, v85 row_newbcast:8 row_mask:0xf bank_mask:0xf
  v_dot2c_f32_bf16_dpp v18, v37, v86 row_newbcast:8 row_mask:0xf bank_mask:0xf
  v_dot2c_f32_bf16_dpp v19, v38, v86 row_newbcast:8 row_mask:0xf bank_mask:0xf
  v_dot2c_f32_bf16_dpp v20, v37, v87 row_newbcast:8 row_mask:0xf bank_mask:0xf
  v_dot2c_f32_bf16_dpp v21, v38, v87 row_newbcast:8 row_mask:0xf bank_mask:0xf
  buffer_load_dwordx4 v[68:71], v7, s[36:39], s44 offen nt
  v_add_f32_dpp v43, v43, v43 row_half_mirror row_mask:0xf bank_mask:0xf
  s_waitcnt vmcnt(11)
  v_dot2c_f32_bf16_dpp v14, v37, v88 row_newbcast:4 row_mask:0xf bank_mask:0xf
  v_dot2c_f32_bf16_dpp v15, v38, v88 row_newbcast:4 row_mask:0xf bank_mask:0xf
  v_dot2c_f32_bf16_dpp v16, v37, v89 row_newbcast:4 row_mask:0xf bank_mask:0xf
  v_dot2c_f32_bf16_dpp v17, v38, v89 row_newbcast:4 row_mask:0xf bank_mask:0xf
  v_dot2c_f32_bf16_dpp v18, v37, v90 row_newbcast:4 row_mask:0xf bank_mask:0xf
  v_dot2c_f32_bf16_dpp v19, v38, v90 row_newbcast:4 row_mask:0xf bank_mask:0xf
  v_dot2c_f32_bf16_dpp v20, v37, v91 row_newbcast:4 row_mask:0xf bank_mask:0xf
  v_dot2c_f32_bf16_dpp v21, v38, v91 row_newbcast:4 row_mask:0xf bank_mask:0xf
  buffer_load_dwordx4 v[72:75], v8, s[36:39], s44 offen nt
  v_mov_b32 v44, v43
  s_waitcnt vmcnt(11)
  v_dot2c_f32_bf16_dpp v14, v37, v92 row_newbcast:12 row_mask:0xf bank_mask:0xf
  v_dot2c_f32_bf16_dpp v15, v38, v92 row_newbcast:12 row_mask:0xf bank_mask:0xf
  v_dot2c_f32_bf16_dpp v16, v37, v93 row_newbcast:12 row_mask:0xf bank_mask:0xf
  v_dot2c_f32_bf16_dpp v17, v38, v93 row_newbcast:12 row_mask:0xf bank_mask:0xf
  v_dot2c_f32_bf16_dpp v18, v37, v94 row_newbcast:12 row_mask:0xf bank_mask:0xf
  v_dot2c_f32_bf16_dpp v19, v38, v94 row_newbcast:12 row_mask:0xf bank_mask:0xf
  v_dot2c_f32_bf16_dpp v20, v37, v95 row_newbcast:12 row_mask:0xf bank_mask:0xf
  v_dot2c_f32_bf16_dpp v21, v38, v95 row_newbcast:12 row_mask:0xf bank_mask:0xf
  buffer_load_dwordx4 v[76:79], v9, s[36:39], s44 offen nt
  v_permlane32_swap_b32 v43, v44
  v_add_f32 v41, v41, v43
  v_add_f32 v41, v41, v44
  s_waitcnt vmcnt(11)
  v_dot2c_f32_bf16_dpp v14, v39, v96 row_newbcast:0 row_mask:0xf bank_mask:0xf
  v_dot2c_f32_bf16_dpp v15, v42, v96 row_newbcast:0 row_mask:0xf bank_mask:0xf
  v_dot2c_f32_bf16_dpp v16, v39, v97 row_newbcast:0 row_mask:0xf bank_mask:0xf
  v_dot2c_f32_bf16_dpp v17, v42, v97 row_newbcast:0 row_mask:0xf bank_mask:0xf
  v_dot2c_f32_bf16_dpp v18, v39, v98 row_newbcast:0 row_mask:0xf bank_mask:0xf
  v_dot2c_f32_bf16_dpp v19, v42, v98 row_newbcast:0 row_mask:0xf bank_mask:0xf
  v_dot2c_f32_bf16_dpp v20, v39, v99 row_newbcast:0 row_mask:0xf bank_mask:0xf
  v_dot2c_f32_bf16_dpp v21, v42, v99 row_newbcast:0 row_mask:0xf bank_mask:0xf
  s_cmp_gt_u32 s45, 2
  s_cbranch_scc1 L_nt2
  s_cmp_ge_u32 s44, 0x200000
  s_cbranch_scc1 L_nt2
  s_mov_b32 s50, 1
  s_mov_b32 s51, 0
  s_atomic_add_x2 s[50:51], s[52:53], 0x0 glc
L_nt2:
  buffer_load_dwordx4 v[80:83], v2, s[40:43], s44 offen nt
  s_waitcnt vmcnt(11)
  v_dot2c_f32_bf16_dpp v14, v39, v100 row_newbcast:8 row_mask:0xf bank_mask:0xf
  v_dot2c_f32_bf16_dpp v15, v42, v100 row_newbcast:8 row_mask:0xf bank_mask:0xf
  v_dot2c_f32_bf16_dpp v16, v39, v101 row_newbcast:8 row_mask:0xf bank_mask:0xf
  v_dot2c_f32_bf16_dpp v17, v42, v101 row_newbcast:8 row_mask:0xf bank_mask:0xf
  v_dot2c_f32_bf16_dpp v18, v39, v102 row_newbcast:8 row_mask:0xf bank_mask:0xf
  v_dot2c_f32_bf16_dpp v19, v42, v102 row_newbcast:8 row_mask:0xf bank_mask:0xf
  v_dot2c_f32_bf16_dpp v20, v39, v103 row_newbcast:8 row_mask:0xf bank_mask:0xf
  v_dot2c_f32_bf16_dpp v21, v42, v103 row_newbcast:8 row_mask:0xf bank_mask:0xf
  buffer_load_dwordx4 v[84:87], v3, s[40:43], s44 offen nt
  s_waitcnt vmcnt(11)
  v_dot2c_f32_bf16_dpp v14, v39, v104 row_newbcast:4 row_mask:0xf bank_mask:0xf
  v_dot2c_f32_bf16_dpp v15, v42, v104 row_newbcast:4 row_mask:0xf bank_mask:0xf
  v_dot2c_f32_bf16_dpp v16, v39, v105 row_newbcast:4 row_mask:0xf bank_mask:0xf
  v_dot2c_f32_bf16_dpp v17, v42, v105 row_newbcast:4 row_mask:0xf bank_mask:0xf
  v_dot2c_f32_bf16_dpp v18, v39, v106 row_newbcast:4 row_mask:0xf bank_mask:0xf
  v_dot2c_f32_bf16_dpp v19, v42, v106 row_newbcast:4 row_mask:0xf bank_mask:0xf
  v_dot2c_f32_bf16_dpp v20, v39, v107 row_newbcast:4 row_mask:0xf bank_mask:0xf
  v_dot2c_f32_bf16_dpp v21, v42, v107 row_newbcast:4 row_mask:0xf bank_mask:0xf
  buffer_load_dwordx4 v[88:91], v4, s[40:43], s44 offen nt
  s_waitcnt vmcnt(11)
  v_dot2c_f32_bf16_dpp v14, v39, v108 row_newbcast:12 row_mask:0xf bank_mask:0xf
  v_dot2c_f32_bf16_dpp v15, v42, v108 row_newbcast:12 row_mask:0xf bank_mask:0xf
  v_dot2c_f32_bf16_dpp v16, v39, v109 row_newbcast:12 row_mask:0xf bank_mask:0xf
  v_dot2c_f32_bf16_dpp v17, v42, v109 row_newbcast:12 row_mask:0xf bank_mask:0xf
  v_dot2c_f32_bf16_dpp v18, v39, v110 row_newbcast:12 row_mask:0xf bank_mask:0xf
  v_dot2c_f32_bf16_dpp v19, v42, v110 row_newbcast:12 row_mask:0xf bank_mask:0xf
  v_dot2c_f32_bf16_dpp v20, v39, v111 row_newbcast:12 row_mask:0xf bank_mask:0xf
  v_dot2c_f32_bf16_dpp v21, v42, v111 row_newbcast:12 row_mask:0xf bank_mask:0xf
  buffer_load_dwordx4 v[92:95], v5, s[40:43], s44 offen nt
  s_mov_b32 s47, s44
  s_cmp_eq_u32 s45, 11
  s_cbranch_scc1 L_sB
  s_cmp_eq_u32 s45, 10
  s_cbranch_scc1 L_sC
  s_cmp_lg_u32 s45, 3
  s_cbranch_scc1 L_sback
  ds_write_b32 v255, v47 offset:592
L_sback:
  s_sub_u32 s45, s45, 1
  s_max_i32 s45, s45, 1
  s_cmp_lt_u32 s47, 0x200000
  s_cbranch_scc1 L_sloop
  s_waitcnt lgkmcnt(0)
  v_mov_b32 v31, 0
  v_mov_b32 v32, 1
  v_permlane32_swap_b32 v14, v18
  v_permlane32_swap_b32 v15, v19
  v_permlane32_swap_b32 v16, v20
  v_permlane32_swap_b32 v17, v21
  v_add_f32 v14, v14, v18
  v_add_f32 v15, v15, v19
  v_add_f32 v16, v16, v20
  v_add_f32 v17, v17, v21
  ds_write_b128 v46, v[14:17] offset:6144
  ds_write_b64 v45, v[40:41] offset:32
  s_mov_b64 exec, 1
  ds_add_rtn_u32 v33, v31, v32 offset:16
  s_mov_b64 exec, -1
  ds_read_b64 v[34:35], v31 offset:24
  ds_read_b128 v[236:239], v31 offset:32
  ds_read_b128 v[240:243], v31 offset:48
  ds_read_b64 v[212:213], v249 offset:6144
  ds_read_b64 v[214:215], v249 offset:6152
  ds_read_b64 v[216:217], v249 offset:6160
  ds_read_b64 v[218:219], v249 offset:7168
  ds_read_b64 v[220:221], v249 offset:7176
  ds_read_b64 v[222:223], v249 offset:7184
  ds_read_b64 v[224:225], v249 offset:8192
  ds_read_b64 v[226:227], v249 offset:8200
  ds_read_b64 v[228:229], v249 offset:8208
  ds_read_b64 v[230:231], v249 offset:9216
  ds_read_b64 v[232:233], v249 offset:9224
  ds_read_b64 v[234:235], v249 offset:9232
  s_waitcnt lgkmcnt(14)
  v_readfirstlane_b32 s7, v33
  s_nop 0
  s_cmp_lg_u32 s7, 3
  s_cbranch_scc1 L_exit
  v_cmp_ne_u32 vcc, s6, v34
  s_cbranch_vccnz L_spc
L_spcok:
  v_xor_b32 v248, v35, v248
  s_waitcnt lgkmcnt(12)
  v_max3_f32 v30, v236, v238, v240
  v_max_f32 v30, v30, v242
  v_sub_f32 v236, v236, v30
  v_sub_f32 v238, v238, v30
  v_sub_f32 v240, v240, v30
  v_sub_f32 v242, v242, v30
  v_exp_f32 v236, v236
  v_exp_f32 v238, v238
  v_exp_f32 v240, v240
  v_exp_f32 v242, v242
  s_nop 0
  v_mul_f32 v31, v236, v237
  v_fmac_f32 v31, v238, v239
  v_fmac_f32 v31, v240, v241
  v_fmac_f32 v31, v242, v243
  v_rcp_f32 v32, v31
  v_log_f32 v33, v31
  s_waitcnt lgkmcnt(0)
  v_pk_mul_f32 v[22:23], v[212:213], v[236:237] op_sel_hi:[1,0]
  v_pk_mul_f32 v[24:25], v[214:215], v[236:237] op_sel_hi:[1,0]
  v_pk_mul_f32 v[26:27], v[216:217], v[236:237] op_sel_hi:[1,0]
  v_pk_fma_f32 v[22:23], v[218:219], v[238:239], v[22:23] op_sel_hi:[1,0,1]
  v_pk_fma_f32 v[24:25], v[220:221], v[238:239], v[24:25] op_sel_hi:[1,0,1]
  v_pk_fma_f32 v[26:27], v[222:223], v[238:239], v[26:27] op_sel_hi:[1,0,1]
  v_pk_fma_f32 v[22:23], v[224:225], v[240:241], v[22:23] op_sel_hi:[1,0,1]
  v_pk_fma_f32 v[24:25], v[226:227], v[240:241], v[24:25] op_sel_hi:[1,0,1]
  v_pk_fma_f32 v[26:27], v[228:229], v[240:241], v[26:27] op_sel_hi:[1,0,1]
  v_pk_fma_f32 v[22:23], v[230:231], v[242:243], v[22:23] op_sel_hi:[1,0,1]
  v_pk_fma_f32 v[24:25], v[232:233], v[242:243], v[24:25] op_sel_hi:[1,0,1]
  v_pk_fma_f32 v[26:27], v[234:235], v[242:243], v[26:27] op_sel_hi:[1,0,1]
  v_add_f32 v33, v33, v30
  v_pk_mul_f32 v[22:23], v[22:23], v[32:33] op_sel_hi:[1,0]
  v_pk_mul_f32 v[24:25], v[24:25], v[32:33] op_sel_hi:[1,0]
  v_pk_mul_f32 v[26:27], v[26:27], v[32:33] op_sel_hi:[1,0]
  v_cvt_pk_bf16_f32 v44, v22, v23
  v_cvt_pk_bf16_f32 v45, v24, v25
  v_cvt_pk_bf16_f32 v46, v26, v27
  v_cndmask_b32 v44, 0, v44, s[64:65]
  v_cndmask_b32 v45, 0, v45, s[60:61]
  v_cndmask_b32 v46, 0, v46, s[60:61]
  v_cndmask_b32 v45, v45, v33, s[58:59]
  s_mov_b32 exec_hi, 0xffff
  global_store_dwordx4 v248, v[44:47], s[32:33] sc1
  v_mov_b32 v30, 0
  v_mov_b32 v31, 5
  ds_write_b32 v30, v31 offset:16
  s_endpgm
L_tkretry:
  s_mov_b32 s48, 262144
L_tkr2:
  s_sleep 8
  s_mov_b32 s50, 1
  s_mov_b32 s51, 0
  s_atomic_add_x2 s[50:51], s[52:53], 0x0 glc
  s_sub_u32 s48, s48, 1
  s_cbranch_scc1 L_exit
  s_waitcnt lgkmcnt(0)
  s_cmp_lg_u32 s51, s6
  s_cbranch_scc1 L_tkr2
  s_branch L_tkok
L_spc:
  s_mov_b32 s48, 262144
L_spc2:
  s_sleep 2
  ds_read_b64 v[34:35], v31 offset:24
  s_sub_u32 s48, s48, 1
  s_cbranch_scc1 L_exit
  s_waitcnt lgkmcnt(0)
  v_cmp_ne_u32 vcc, s6, v34
  s_cbranch_vccnz L_spc2
  s_branch L_spcok
L_snw:
  s_mov_b32 s50, 262144
  v_mov_b32 v30, 0
L_snw2:
  global_load_dword v31, v30, s[30:31] sc1
  s_sub_u32 s50, s50, 1
  s_cbranch_scc1 L_exit
  s_waitcnt vmcnt(0)
  v_readfirstlane_b32 s6, v31
  s_nop 0
  s_and_b32 s48, s6, 0x3fff
  s_lshr_b32 s49, s6, 2
  s_and_b32 s49, s49, 0x0fffc000
  s_or_b32 s48, s48, s49
  s_sub_u32 s48, s48, s98
  s_add_u32 s48, s48, 1500
  s_bfe_u32 s48, s48, 0x1001b
  s_bfe_u32 s49, s6, 0x1000f
  s_cmp_gt_u32 s49, s48
  s_cbranch_scc1 L_snok
  s_cmp_gt_u32 s50, 261944
  s_cbranch_scc1 L_snw2
  s_cmp_eq_u32 s6, 0
  s_cbranch_scc1 L_snw2
  s_branch L_snok
L_sB:
  v_dot2_f32_bf16 v22, v112, v10, 0
  v_dot2_f32_bf16 v22, v113, v11, v22
  v_dot2_f32_bf16 v22, v114, v12, v22
  v_dot2_f32_bf16 v22, v115, v13, v22
  v_dot2_f32_bf16 v23, v116, v10, 0
  v_dot2_f32_bf16 v23, v117, v11, v23
  v_dot2_f32_bf16 v23, v118, v12, v23
  v_dot2_f32_bf16 v23, v119, v13, v23
  v_dot2_f32_bf16 v24, v120, v10, 0
  v_dot2_f32_bf16 v24, v121, v11, v24
  v_dot2_f32_bf16 v24, v122, v12, v24
  v_dot2_f32_bf16 v24, v123, v13, v24
  v_dot2_f32_bf16 v25, v124, v10, 0
  v_dot2_f32_bf16 v25, v125, v11, v25
  v_dot2_f32_bf16 v25, v126, v12, v25
  v_dot2_f32_bf16 v25, v127, v13, v25
  v_dot2_f32_bf16 v26, v128, v10, 0
  v_dot2_f32_bf16 v26, v129, v11, v26
  v_dot2_f32_bf16 v26, v130, v12, v26
  v_dot2_f32_bf16 v26, v131, v13, v26
  v_dot2_f32_bf16 v27, v132, v10, 0
  v_dot2_f32_bf16 v27, v133, v11, v27
  v_dot2_f32_bf16 v27, v134, v12, v27
  v_dot2_f32_bf16 v27, v135, v13, v27
  v_dot2_f32_bf16 v28, v136, v10, 0
  v_dot2_f32_bf16 v28, v137, v11, v28
  v_dot2_f32_bf16 v28, v138, v12, v28
  v_dot2_f32_bf16 v28, v139, v13, v28
  v_dot2_f32_bf16 v29, v140, v10, 0
  v_dot2_f32_bf16 v29, v141, v11, v29
  v_dot2_f32_bf16 v29, v142, v12, v29
  v_dot2_f32_bf16 v29, v143, v13, v29
  v_add_f32_dpp v22, v22, v22 row_ror:8 row_mask:0xf bank_mask:0x3
  v_add_f32_dpp v22, v23, v23 row_ror:8 row_mask:0xf bank_mask:0xc
  v_add_f32_dpp v24, v24, v24 row_ror:8 row_mask:0xf bank_mask:0x3
  v_add_f32_dpp v24, v25, v25 row_ror:8 row_mask:0xf bank_mask:0xc
  v_add_f32_dpp v26, v26, v26 row_ror:8 row_mask:0xf bank_mask:0x3
  v_add_f32_dpp v26, v27, v27 row_ror:8 row_mask:0xf bank_mask:0xc
  v_add_f32_dpp v28, v28, v28 row_ror:8 row_mask:0xf bank_mask:0x3
  v_add_f32_dpp v28, v29, v29 row_ror:8 row_mask:0xf bank_mask:0xc
  v_add_f32_dpp v22, v22, v22 row_half_mirror row_mask:0xf bank_mask:0x5
  v_add_f32_dpp v22, v24, v24 row_half_mirror row_mask:0xf bank_mask:0xa
  v_add_f32_dpp v26, v26, v26 row_half_mirror row_mask:0xf bank_mask:0x5
  v_add_f32_dpp v26, v28, v28 row_half_mirror row_mask:0xf bank_mask:0xa
  s_nop 1
  v_permlane16_swap_b32 v22, v26
  v_add_f32 v22, v22, v26
  s_nop 1
  v_add_f32_dpp v22, v22, v22 quad_perm:[1,0,3,2] row_mask:0xf bank_mask:0xf
  s_nop 1
  v_add_f32_dpp v22, v22, v22 quad_perm:[2,3,0,1] row_mask:0xf bank_mask:0xf
  v_cvt_pk_bf16_f32 v30, 0, v22
  s_nop 1
  v_max_f32_dpp v31, v30, v30 row_ror:8 row_mask:0xf bank_mask:0xf
  s_nop 1
  v_max_f32_dpp v31, v31, v31 row_half_mirror row_mask:0xf bank_mask:0xf
  v_mov_b32 v32, v31
  s_nop 1
  v_permlane16_swap_b32 v31, v32
  v_max_f32 v31, v31, v32
  v_mov_b32 v32, v31
  s_nop 1
  v_permlane32_swap_b32 v31, v32
  v_max_f32 v31, v31, v32
  v_mul_f32 v31, s46, v31
  v_max_f32 v33, v40, v31
  v_fma_f32 v35, v30, s46, -v33
  v_sub_f32 v34, v40, v33
  v_exp_f32 v35, v35
  v_exp_f32 v34, v34
  v_mov_b32 v40, v33
  v_mov_b32 v36, v35
  v_mul_f32 v14, v14, v34
  v_mul_f32 v15, v15, v34
  v_permlane16_swap_b32 v35, v36
  v_mul_f32 v16, v16, v34
  v_mul_f32 v17, v17, v34
  v_mul_f32 v18, v18, v34
  v_mul_f32 v19, v19, v34
  v_mul_f32 v20, v20, v34
  v_mul_f32 v21, v21, v34
  v_cvt_pk_bf16_f32 v37, v35, 0
  v_cvt_pk_bf16_f32 v38, 0, v35
  v_cvt_pk_bf16_f32 v39, v36, 0
  v_cvt_pk_bf16_f32 v42, 0, v36
  v_add_f32 v43, v35, v36
  v_mul_f32 v41, v41, v34
  v_dot2c_f32_bf16_dpp v14, v37, v144 row_newbcast:0 row_mask:0xf bank_mask:0xf
  v_dot2c_f32_bf16_dpp v15, v38, v144 row_newbcast:0 row_mask:0xf bank_mask:0xf
  v_dot2c_f32_bf16_dpp v16, v37, v145 row_newbcast:0 row_mask:0xf bank_mask:0xf
  v_dot2c_f32_bf16_dpp v17, v38, v145 row_newbcast:0 row_mask:0xf bank_mask:0xf
  v_dot2c_f32_bf16_dpp v18, v37, v146 row_newbcast:0 row_mask:0xf bank_mask:0xf
  v_dot2c_f32_bf16_dpp v19, v38, v146 row_newbcast:0 row_mask:0xf bank_mask:0xf
  v_dot2c_f32_bf16_dpp v20, v37, v147 row_newbcast:0 row_mask:0xf bank_mask:0xf
  v_dot2c_f32_bf16_dpp v21, v38, v147 row_newbcast:0 row_mask:0xf bank_mask:0xf
  v_add_f32_dpp v43, v43, v43 row_ror:8 row_mask:0xf bank_mask:0xf
  v_dot2c_f32_bf16_dpp v14, v37, v148 row_newbcast:8 row_mask:0xf bank_mask:0xf
  v_dot2c_f32_bf16_dpp v15, v38, v148 row_newbcast:8 row_mask:0xf bank_mask:0xf
  v_dot2c_f32_bf16_dpp v16, v37, v149 row_newbcast:8 row_mask:0xf bank_mask:0xf
  v_dot2c_f32_bf16_dpp v17, v38, v149 row_newbcast:8 row_mask:0xf bank_mask:0xf
  v_dot2c_f32_bf16_dpp v18, v37, v150 row_newbcast:8 row_mask:0xf bank_mask:0xf
  v_dot2c_f32_bf16_dpp v19, v38, v150 row_newbcast:8 row_mask:0xf bank_mask:0xf
  v_dot2c_f32_bf16_dpp v20, v37, v151 row_newbcast:8 row_mask:0xf bank_mask:0xf
  v_dot2c_f32_bf16_dpp v21, v38, v151 row_newbcast:8 row_mask:0xf bank_mask:0xf
  v_add_f32_dpp v43, v43, v43 row_half_mirror row_mask:0xf bank_mask:0xf
  v_dot2c_f32_bf16_dpp v14, v37, v152 row_newbcast:4 row_mask:0xf bank_mask:0xf
  v_dot2c_f32_bf16_dpp v15, v38, v152 row_newbcast:4 row_mask:0xf bank_mask:0xf
  v_dot2c_f32_bf16_dpp v16, v37, v153 row_newbcast:4 row_mask:0xf bank_mask:0xf
  v_dot2c_f32_bf16_dpp v17, v38, v153 row_newbcast:4 row_mask:0xf bank_mask:0xf
  v_dot2c_f32_bf16_dpp v18, v37, v154 row_newbcast:4 row_mask:0xf bank_mask:0xf
  v_dot2c_f32_bf16_dpp v19, v38, v154 row_newbcast:4 row_mask:0xf bank_mask:0xf
  v_dot2c_f32_bf16_dpp v20, v37, v155 row_newbcast:4 row_mask:0xf bank_mask:0xf
  v_dot2c_f32_bf16_dpp v21, v38, v155 row_newbcast:4 row_mask:0xf bank_mask:0xf
  v_mov_b32 v44, v43
  v_dot2c_f32_bf16_dpp v14, v37, v156 row_newbcast:12 row_mask:0xf bank_mask:0xf
  v_dot2c_f32_bf16_dpp v15, v38, v156 row_newbcast:12 row_mask:0xf bank_mask:0xf
  v_dot2c_f32_bf16_dpp v16, v37, v157 row_newbcast:12 row_mask:0xf bank_mask:0xf
  v_dot2c_f32_bf16_dpp v17, v38, v157 row_newbcast:12 row_mask:0xf bank_mask:0xf
  v_dot2c_f32_bf16_dpp v18, v37, v158 row_newbcast:12 row_mask:0xf bank_mask:0xf
  v_dot2c_f32_bf16_dpp v19, v38, v158 row_newbcast:12 row_mask:0xf bank_mask:0xf
  v_dot2c_f32_bf16_dpp v20, v37, v159 row_newbcast:12 row_mask:0xf bank_mask:0xf
  v_dot2c_f32_bf16_dpp v21, v38, v159 row_newbcast:12 row_mask:0xf bank_mask:0xf
  v_permlane32_swap_b32 v43, v44
  v_add_f32 v41, v41, v43
  v_add_f32 v41, v41, v44
  v_dot2c_f32_bf16_dpp v14, v39, v160 row_newbcast:0 row_mask:0xf bank_mask:0xf
  v_dot2c_f32_bf16_dpp v15, v42, v160 row_newbcast:0 row_mask:0xf bank_mask:0xf
  v_dot2c_f32_bf16_dpp v16, v39, v161 row_newbcast:0 row_mask:0xf bank_mask:0xf
  v_dot2c_f32_bf16_dpp v17, v42, v161 row_newbcast:0 row_mask:0xf bank_mask:0xf
  v_dot2c_f32_bf16_dpp v18, v39, v162 row_newbcast:0 row_mask:0xf bank_mask:0xf
  v_dot2c_f32_bf16_dpp v19, v42, v162 row_newbcast:0 row_mask:0xf bank_mask:0xf
  v_dot2c_f32_bf16_dpp v20, v39, v163 row_newbcast:0 row_mask:0xf bank_mask:0xf
  v_dot2c_f32_bf16_dpp v21, v42, v163 row_newbcast:0 row_mask:0xf bank_mask:0xf
  v_dot2c_f32_bf16_dpp v14, v39, v164 row_newbcast:8 row_mask:0xf bank_mask:0xf
  v_dot2c_f32_bf16_dpp v15, v42, v164 row_newbcast:8 row_mask:0xf bank_mask:0xf
  v_dot2c_f32_bf16_dpp v16, v39, v165 row_newbcast:8 row_mask:0xf bank_mask:0xf
  v_dot2c_f32_bf16_dpp v17, v42, v165 row_newbcast:8 row_mask:0xf bank_mask:0xf
  v_dot2c_f32_bf16_dpp v18, v39, v166 row_newbcast:8 row_mask:0xf bank_mask:0xf
  v_dot2c_f32_bf16_dpp v19, v42, v166 row_newbcast:8 row_mask:0xf bank_mask:0xf
  v_dot2c_f32_bf16_dpp v20, v39, v167 row_newbcast:8 row_mask:0xf bank_mask:0xf
  v_dot2c_f32_bf16_dpp v21, v42, v167 row_newbcast:8 row_mask:0xf bank_mask:0xf
  v_dot2c_f32_bf16_dpp v14, v39, v168 row_newbcast:4 row_mask:0xf bank_mask:0xf
  v_dot2c_f32_bf16_dpp v15, v42, v168 row_newbcast:4 row_mask:0xf bank_mask:0xf
  v_dot2c_f32_bf16_dpp v16, v39, v169 row_newbcast:4 row_mask:0xf bank_mask:0xf
  v_dot2c_f32_bf16_dpp v17, v42, v169 row_newbcast:4 row_mask:0xf bank_mask:0xf
  v_dot2c_f32_bf16_dpp v18, v39, v170 row_newbcast:4 row_mask:0xf bank_mask:0xf
  v_dot2c_f32_bf16_dpp v19, v42, v170 row_newbcast:4 row_mask:0xf bank_mask:0xf
  v_dot2c_f32_bf16_dpp v20, v39, v171 row_newbcast:4 row_mask:0xf bank_mask:0xf
  v_dot2c_f32_bf16_dpp v21, v42, v171 row_newbcast:4 row_mask:0xf bank_mask:0xf
  v_dot2c_f32_bf16_dpp v14, v39, v172 row_newbcast:12 row_mask:0xf bank_mask:0xf
  v_dot2c_f32_bf16_dpp v15, v42, v172 row_newbcast:12 row_mask:0xf bank_mask:0xf
  v_dot2c_f32_bf16_dpp v16, v39, v173 row_newbcast:12 row_mask:0xf bank_mask:0xf
  v_dot2c_f32_bf16_dpp v17, v42, v173 row_newbcast:12 row_mask:0xf bank_mask:0xf
  v_dot2c_f32_bf16_dpp v18, v39, v174 row_newbcast:12 row_mask:0xf bank_mask:0xf
  v_dot2c_f32_bf16_dpp v19, v42, v174 row_newbcast:12 row_mask:0xf bank_mask:0xf
  v_dot2c_f32_bf16_dpp v20, v39, v175 row_newbcast:12 row_mask:0xf bank_mask:0xf
  v_dot2c_f32_bf16_dpp v21, v42, v175 row_newbcast:12 row_mask:0xf bank_mask:0xf
  s_branch L_sback
L_sC:
  v_dot2_f32_bf16 v22, v176, v10, 0
  v_dot2_f32_bf16 v22, v177, v11, v22
  v_dot2_f32_bf16 v22, v178, v12, v22
  v_dot2_f32_bf16 v22, v179, v13, v22
  v_dot2_f32_bf16 v23, v180, v10, 0
  v_dot2_f32_bf16 v23, v181, v11, v23
  v_dot2_f32_bf16 v23, v182, v12, v23
  v_dot2_f32_bf16 v23, v183, v13, v23
  v_dot2_f32_bf16 v24, v184, v10, 0
  v_dot2_f32_bf16 v24, v185, v11, v24
  v_dot2_f32_bf16 v24, v186, v12, v24
  v_dot2_f32_bf16 v24, v187, v13, v24
  v_dot2_f32_bf16 v25, v188, v10, 0
  v_dot2_f32_bf16 v25, v189, v11, v25
  v_dot2_f32_bf16 v25, v190, v12, v25
  v_dot2_f32_bf16 v25, v191, v13, v25
  v_dot2_f32_bf16 v26, v192, v10, 0
  v_dot2_f32_bf16 v26, v193, v11, v26
  v_dot2_f32_bf16 v26, v194, v12, v26
  v_dot2_f32_bf16 v26, v195, v13, v26
  v_dot2_f32_bf16 v27, v196, v10, 0
  v_dot2_f32_bf16 v27, v197, v11, v27
  v_dot2_f32_bf16 v27, v198, v12, v27
  v_dot2_f32_bf16 v27, v199, v13, v27
  v_dot2_f32_bf16 v28, v200, v10, 0
  v_dot2_f32_bf16 v28, v201, v11, v28
  v_dot2_f32_bf16 v28, v202, v12, v28
  v_dot2_f32_bf16 v28, v203, v13, v28
  v_dot2_f32_bf16 v29, v204, v10, 0
  v_dot2_f32_bf16 v29, v205, v11, v29
  v_dot2_f32_bf16 v29, v206, v12, v29
  v_dot2_f32_bf16 v29, v207, v13, v29
  v_add_f32_dpp v22, v22, v22 row_ror:8 row_mask:0xf bank_mask:0x3
  v_add_f32_dpp v22, v23, v23 row_ror:8 row_mask:0xf bank_mask:0xc
  v_add_f32_dpp v24, v24, v24 row_ror:8 row_mask:0xf bank_mask:0x3
  v_add_f32_dpp v24, v25, v25 row_ror:8 row_mask:0xf bank_mask:0xc
  v_add_f32_dpp v26, v26, v26 row_ror:8 row_mask:0xf bank_mask:0x3
  v_add_f32_dpp v26, v27, v27 row_ror:8 row_mask:0xf bank_mask:0xc
  v_add_f32_dpp v28, v28, v28 row_ror:8 row_mask:0xf bank_mask:0x3
  v_add_f32_dpp v28, v29, v29 row_ror:8 row_mask:0xf bank_mask:0xc
  v_add_f32_dpp v22, v22, v22 row_half_mirror row_mask:0xf bank_mask:0x5
  v_add_f32_dpp v22, v24, v24 row_half_mirror row_mask:0xf bank_mask:0xa
  v_add_f32_dpp v26, v26, v26 row_half_mirror row_mask:0xf bank_mask:0x5
  v_add_f32_dpp v26, v28, v28 row_half_mirror row_mask:0xf bank_mask:0xa
  s_nop 1
  v_permlane16_swap_b32 v22, v26
  v_add_f32 v22, v22, v26
  s_nop 1
  v_add_f32_dpp v22, v22, v22 quad_perm:[1,0,3,2] row_mask:0xf bank_mask:0xf
  s_nop 1
  v_add_f32_dpp v22, v22, v22 quad_perm:[2,3,0,1] row_mask:0xf bank_mask:0xf
  v_cvt_pk_bf16_f32 v30, 0, v22
  s_nop 1
  v_max_f32_dpp v31, v30, v30 row_ror:8 row_mask:0xf bank_mask:0xf
  s_nop 1
  v_max_f32_dpp v31, v31, v31 row_half_mirror row_mask:0xf bank_mask:0xf
  v_mov_b32 v32, v31
  s_nop 1
  v_permlane16_swap_b32 v31, v32
  v_max_f32 v31, v31, v32
  v_mov_b32 v32, v31
  s_nop 1
  v_permlane32_swap_b32 v31, v32
  v_max_f32 v31, v31, v32
  v_mul_f32 v31, s46, v31
  v_max_f32 v33, v40, v31
  v_fma_f32 v35, v30, s46, -v33
  v_sub_f32 v34, v40, v33
  v_exp_f32 v35, v35
  v_exp_f32 v34, v34
  v_mov_b32 v40, v33
  v_mov_b32 v36, v35
  v_mul_f32 v14, v14, v34
  v_mul_f32 v15, v15, v34
  v_permlane16_swap_b32 v35, v36
  v_mul_f32 v16, v16, v34
  v_mul_f32 v17, v17, v34
  v_mul_f32 v18, v18, v34
  v_mul_f32 v19, v19, v34
  v_mul_f32 v20, v20, v34
  v_mul_f32 v21, v21, v34
  v_cvt_pk_bf16_f32 v37, v35, 0
  v_cvt_pk_bf16_f32 v38, 0, v35
  v_cvt_pk_bf16_f32 v39, v36, 0
  v_cvt_pk_bf16_f32 v42, 0, v36
  v_add_f32 v43, v35, v36
  v_mul_f32 v41, v41, v34
  v_dot2c_f32_bf16_dpp v14, v37, v208 row_newbcast:0 row_mask:0xf bank_mask:0xf
  v_dot2c_f32_bf16_dpp v15, v38, v208 row_newbcast:0 row_mask:0xf bank_mask:0xf
  v_dot2c_f32_bf16_dpp v16, v37, v209 row_newbcast:0 row_mask:0xf bank_mask:0xf
  v_dot2c_f32_bf16_dpp v17, v38, v209 row_newbcast:0 row_mask:0xf bank_mask:0xf
  v_dot2c_f32_bf16_dpp v18, v37, v210 row_newbcast:0 row_mask:0xf bank_mask:0xf
  v_dot2c_f32_bf16_dpp v19, v38, v210 row_newbcast:0 row_mask:0xf bank_mask:0xf
  v_dot2c_f32_bf16_dpp v20, v37, v211 row_newbcast:0 row_mask:0xf bank_mask:0xf
  v_dot2c_f32_bf16_dpp v21, v38, v211 row_newbcast:0 row_mask:0xf bank_mask:0xf
  v_add_f32_dpp v43, v43, v43 row_ror:8 row_mask:0xf bank_mask:0xf
  v_dot2c_f32_bf16_dpp v14, v37, v212 row_newbcast:8 row_mask:0xf bank_mask:0xf
  v_dot2c_f32_bf16_dpp v15, v38, v212 row_newbcast:8 row_mask:0xf bank_mask:0xf
  v_dot2c_f32_bf16_dpp v16, v37, v213 row_newbcast:8 row_mask:0xf bank_mask:0xf
  v_dot2c_f32_bf16_dpp v17, v38, v213 row_newbcast:8 row_mask:0xf bank_mask:0xf
  v_dot2c_f32_bf16_dpp v18, v37, v214 row_newbcast:8 row_mask:0xf bank_mask:0xf
  v_dot2c_f32_bf16_dpp v19, v38, v214 row_newbcast:8 row_mask:0xf bank_mask:0xf
  v_dot2c_f32_bf16_dpp v20, v37, v215 row_newbcast:8 row_mask:0xf bank_mask:0xf
  v_dot2c_f32_bf16_dpp v21, v38, v215 row_newbcast:8 row_mask:0xf bank_mask:0xf
  v_add_f32_dpp v43, v43, v43 row_half_mirror row_mask:0xf bank_mask:0xf
  v_dot2c_f32_bf16_dpp v14, v37, v216 row_newbcast:4 row_mask:0xf bank_mask:0xf
  v_dot2c_f32_bf16_dpp v15, v38, v216 row_newbcast:4 row_mask:0xf bank_mask:0xf
  v_dot2c_f32_bf16_dpp v16, v37, v217 row_newbcast:4 row_mask:0xf bank_mask:0xf
  v_dot2c_f32_bf16_dpp v17, v38, v217 row_newbcast:4 row_mask:0xf bank_mask:0xf
  v_dot2c_f32_bf16_dpp v18, v37, v218 row_newbcast:4 row_mask:0xf bank_mask:0xf
  v_dot2c_f32_bf16_dpp v19, v38, v218 row_newbcast:4 row_mask:0xf bank_mask:0xf
  v_dot2c_f32_bf16_dpp v20, v37, v219 row_newbcast:4 row_mask:0xf bank_mask:0xf
  v_dot2c_f32_bf16_dpp v21, v38, v219 row_newbcast:4 row_mask:0xf bank_mask:0xf
  v_mov_b32 v44, v43
  v_dot2c_f32_bf16_dpp v14, v37, v220 row_newbcast:12 row_mask:0xf bank_mask:0xf
  v_dot2c_f32_bf16_dpp v15, v38, v220 row_newbcast:12 row_mask:0xf bank_mask:0xf
  v_dot2c_f32_bf16_dpp v16, v37, v221 row_newbcast:12 row_mask:0xf bank_mask:0xf
  v_dot2c_f32_bf16_dpp v17, v38, v221 row_newbcast:12 row_mask:0xf bank_mask:0xf
  v_dot2c_f32_bf16_dpp v18, v37, v222 row_newbcast:12 row_mask:0xf bank_mask:0xf
  v_dot2c_f32_bf16_dpp v19, v38, v222 row_newbcast:12 row_mask:0xf bank_mask:0xf
  v_dot2c_f32_bf16_dpp v20, v37, v223 row_newbcast:12 row_mask:0xf bank_mask:0xf
  v_dot2c_f32_bf16_dpp v21, v38, v223 row_newbcast:12 row_mask:0xf bank_mask:0xf
  v_permlane32_swap_b32 v43, v44
  v_add_f32 v41, v41, v43
  v_add_f32 v41, v41, v44
  v_dot2c_f32_bf16_dpp v14, v39, v224 row_newbcast:0 row_mask:0xf bank_mask:0xf
  v_dot2c_f32_bf16_dpp v15, v42, v224 row_newbcast:0 row_mask:0xf bank_mask:0xf
  v_dot2c_f32_bf16_dpp v16, v39, v225 row_newbcast:0 row_mask:0xf bank_mask:0xf
  v_dot2c_f32_bf16_dpp v17, v42, v225 row_newbcast:0 row_mask:0xf bank_mask:0xf
  v_dot2c_f32_bf16_dpp v18, v39, v226 row_newbcast:0 row_mask:0xf bank_mask:0xf
  v_dot2c_f32_bf16_dpp v19, v42, v226 row_newbcast:0 row_mask:0xf bank_mask:0xf
  v_dot2c_f32_bf16_dpp v20, v39, v227 row_newbcast:0 row_mask:0xf bank_mask:0xf
  v_dot2c_f32_bf16_dpp v21, v42, v227 row_newbcast:0 row_mask:0xf bank_mask:0xf
  v_dot2c_f32_bf16_dpp v14, v39, v228 row_newbcast:8 row_mask:0xf bank_mask:0xf
  v_dot2c_f32_bf16_dpp v15, v42, v228 row_newbcast:8 row_mask:0xf bank_mask:0xf
  v_dot2c_f32_bf16_dpp v16, v39, v229 row_newbcast:8 row_mask:0xf bank_mask:0xf
  v_dot2c_f32_bf16_dpp v17, v42, v229 row_newbcast:8 row_mask:0xf bank_mask:0xf
  v_dot2c_f32_bf16_dpp v18, v39, v230 row_newbcast:8 row_mask:0xf bank_mask:0xf
  v_dot2c_f32_bf16_dpp v19, v42, v230 row_newbcast:8 row_mask:0xf bank_mask:0xf
  v_dot2c_f32_bf16_dpp v20, v39, v231 row_newbcast:8 row_mask:0xf bank_mask:0xf
  v_dot2c_f32_bf16_dpp v21, v42, v231 row_newbcast:8 row_mask:0xf bank_mask:0xf
  v_dot2c_f32_bf16_dpp v14, v39, v232 row_newbcast:4 row_mask:0xf bank_mask:0xf
  v_dot2c_f32_bf16_dpp v15, v42, v232 row_newbcast:4 row_mask:0xf bank_mask:0xf
  v_dot2c_f32_bf16_dpp v16, v39, v233 row_newbcast:4 row_mask:0xf bank_mask:0xf
  v_dot2c_f32_bf16_dpp v17, v42, v233 row_newbcast:4 row_mask:0xf bank_mask:0xf
  v_dot2c_f32_bf16_dpp v18, v39, v234 row_newbcast:4 row_mask:0xf bank_mask:0xf
  v_dot2c_f32_bf16_dpp v19, v42, v234 row_newbcast:4 row_mask:0xf bank_mask:0xf
  v_dot2c_f32_bf16_dpp v20, v39, v235 row_newbcast:4 row_mask:0xf bank_mask:0xf
  v_dot2c_f32_bf16_dpp v21, v42, v235 row_newbcast:4 row_mask:0xf bank_mask:0xf
  v_dot2c_f32_bf16_dpp v14, v39, v236 row_newbcast:12 row_mask:0xf bank_mask:0xf
  v_dot2c_f32_bf16_dpp v15, v42, v236 row_newbcast:12 row_mask:0xf bank_mask:0xf
  v_dot2c_f32_bf16_dpp v16, v39, v237 row_newbcast:12 row_mask:0xf bank_mask:0xf
  v_dot2c_f32_bf16_dpp v17, v42, v237 row_newbcast:12 row_mask:0xf bank_mask:0xf
  v_dot2c_f32_bf16_dpp v18, v39, v238 row_newbcast:12 row_mask:0xf bank_mask:0xf
  v_dot2c_f32_bf16_dpp v19, v42, v238 row_newbcast:12 row_mask:0xf bank_mask:0xf
  v_dot2c_f32_bf16_dpp v20, v39, v239 row_newbcast:12 row_mask:0xf bank_mask:0xf
  v_dot2c_f32_bf16_dpp v21, v42, v239 row_newbcast:12 row_mask:0xf bank_mask:0xf
  s_branch L_sback
L_helper:
  s_setprio 3
  s_sub_u32 s34, s3, 4
  v_and_b32 v1, 63, v0
  s_cmp_eq_u32 s5, 0
  s_cbranch_scc1 L_hnp
  v_lshrrev_b32 v2, 4, v1
  v_and_b32 v3, 15, v1
  v_mul_u32_u24 v4, 896, v2
  v_lshl_add_u32 v4, v3, 4, v4
  v_cmp_gt_u32 s[60:61], 14, v3
  v_bfrev_b32 v7, 1
  v_lshrrev_b32 v5, 3, v1
  v_and_b32 v6, 7, v1
  v_cndmask_b32 v4, v7, v4, s[60:61]
  s_mov_b32 s7, 114688
  v_mul_lo_u32 v56, s7, v5
  v_lshl_add_u32 v56, v6, 4, v56
  s_add_u32 s40, s34, 0
  s_and_b32 s40, s40, 3
  s_mul_i32 s40, s40, 224
  s_add_u32 s41, s34, 1
  s_and_b32 s41, s41, 3
  s_mul_i32 s41, s41, 224
  s_add_u32 s42, s34, 2
  s_and_b32 s42, s42, 3
  s_mul_i32 s42, s42, 224
  s_add_u32 s43, s34, 3
  s_and_b32 s43, s43, 3
  s_mul_i32 s43, s43, 224
  s_mul_i32 s48, s34, 917504
  s_lshl_b32 s49, s4, 7
  s_add_u32 s48, s48, s49
  s_mov_b32 s38, 3584
  s_mov_b32 s39, 0x20000
  s_mov_b32 s46, 3670016
  s_mov_b32 s47, 0x20000
  s_waitcnt lgkmcnt(0)
  s_mov_b32 s35, s98
  s_mov_b32 s36, s8
  s_mov_b32 s37, s9
  s_mov_b32 s44, s14
  s_mov_b32 s45, s15
  buffer_load_dwordx4 v[8:11], v4, s[36:39], s40 offen
  buffer_load_dwordx4 v[12:15], v4, s[36:39], s41 offen
  buffer_load_dwordx4 v[16:19], v4, s[36:39], s42 offen
  buffer_load_dwordx4 v[20:23], v4, s[36:39], s43 offen
  buffer_load_dwordx4 v[100:103], v56, s[44:47], s48 offen nt
  s_add_u32 s48, s48, 8192
  buffer_load_dwordx4 v[104:107], v56, s[44:47], s48 offen nt
  s_add_u32 s48, s48, 8192
  buffer_load_dwordx4 v[108:111], v56, s[44:47], s48 offen nt
  s_add_u32 s48, s48, 8192
  buffer_load_dwordx4 v[112:115], v56, s[44:47], s48 offen nt
  s_add_u32 s48, s48, 8192
  buffer_load_dwordx4 v[116:119], v56, s[44:47], s48 offen nt
  s_add_u32 s48, s48, 8192
  buffer_load_dwordx4 v[120:123], v56, s[44:47], s48 offen nt
  s_add_u32 s48, s48, 8192
  buffer_load_dwordx4 v[124:127], v56, s[44:47], s48 offen nt
  s_add_u32 s48, s48, 8192
  buffer_load_dwordx4 v[128:131], v56, s[44:47], s48 offen nt
  s_add_u32 s48, s48, 8192
  buffer_load_dwordx4 v[132:135], v56, s[44:47], s48 offen nt
  s_add_u32 s48, s48, 8192
  buffer_load_dwordx4 v[136:139], v56, s[44:47], s48 offen nt
  s_add_u32 s48, s48, 8192
  buffer_load_dwordx4 v[140:143], v56, s[44:47], s48 offen nt
  s_add_u32 s48, s48, 8192
  buffer_load_dwordx4 v[144:147], v56, s[44:47], s48 offen nt
  s_add_u32 s48, s48, 8192
  buffer_load_dwordx4 v[148:151], v56, s[44:47], s48 offen nt
  s_add_u32 s48, s48, 8192
  buffer_load_dwordx4 v[152:155], v56, s[44:47], s48 offen nt
  s_mov_b32 s62, 0x3b124925
  s_mov_b32 s63, 0x3727c5ac
  s_mov_b32 s64, 0x05040100
  s_mov_b32 s65, 0x07060302
  s_lshl_b32 s18, s34, 10
  v_lshl_add_u32 v57, v1, 4, s18
  v_mul_u32_u24 v58, 28, v5
  v_add_u32 v58, s18, v58
  s_waitcnt vmcnt(14)
  v_lshlrev_b32 v24, 16, v8
  v_and_b32 v25, 0xffff0000, v8
  v_lshlrev_b32 v26, 16, v9
  v_and_b32 v27, 0xffff0000, v9
  v_lshlrev_b32 v28, 16, v10
  v_and_b32 v29, 0xffff0000, v10
  v_lshlrev_b32 v30, 16, v11
  v_and_b32 v31, 0xffff0000, v11
  v_lshlrev_b32 v32, 16, v12
  v_and_b32 v33, 0xffff0000, v12
  v_lshlrev_b32 v34, 16, v13
  v_and_b32 v35, 0xffff0000, v13
  v_lshlrev_b32 v36, 16, v14
  v_and_b32 v37, 0xffff0000, v14
  v_lshlrev_b32 v38, 16, v15
  v_and_b32 v39, 0xffff0000, v15
  v_lshlrev_b32 v40, 16, v16
  v_and_b32 v41, 0xffff0000, v16
  v_lshlrev_b32 v42, 16, v17
  v_and_b32 v43, 0xffff0000, v17
  v_lshlrev_b32 v44, 16, v18
  v_and_b32 v45, 0xffff0000, v18
  v_lshlrev_b32 v46, 16, v19
  v_and_b32 v47, 0xffff0000, v19
  v_lshlrev_b32 v48, 16, v20
  v_and_b32 v49, 0xffff0000, v20
  v_lshlrev_b32 v50, 16, v21
  v_and_b32 v51, 0xffff0000, v21
  v_lshlrev_b32 v52, 16, v22
  v_and_b32 v53, 0xffff0000, v22
  v_lshlrev_b32 v54, 16, v23
  v_and_b32 v55, 0xffff0000, v23
  s_nop 0
  v_mov_b32_dpp v76, v24 row_newbcast:0 row_mask:0xf bank_mask:0xf
  v_pk_add_f32 v[82:83], v[24:25], v[76:77] op_sel_hi:[1,0] neg_lo:[0,1] neg_hi:[0,1]
  v_pk_mul_f32 v[80:81], v[82:83], v[82:83]
  v_mov_b32 v78, v82
  v_mov_b32 v79, v83
  v_pk_add_f32 v[84:85], v[26:27], v[76:77] op_sel_hi:[1,0] neg_lo:[0,1] neg_hi:[0,1]
  v_pk_fma_f32 v[80:81], v[84:85], v[84:85], v[80:81]
  v_pk_add_f32 v[78:79], v[78:79], v[84:85]
  v_pk_add_f32 v[82:83], v[28:29], v[76:77] op_sel_hi:[1,0] neg_lo:[0,1] neg_hi:[0,1]
  v_pk_fma_f32 v[80:81], v[82:83], v[82:83], v[80:81]
  v_pk_add_f32 v[78:79], v[78:79], v[82:83]
  v_pk_add_f32 v[84:85], v[30:31], v[76:77] op_sel_hi:[1,0] neg_lo:[0,1] neg_hi:[0,1]
  v_pk_fma_f32 v[80:81], v[84:85], v[84:85], v[80:81]
  v_pk_add_f32 v[78:79], v[78:79], v[84:85]
  v_pk_add_f32 v[82:83], v[32:33], v[76:77] op_sel_hi:[1,0] neg_lo:[0,1] neg_hi:[0,1]
  v_pk_fma_f32 v[80:81], v[82:83], v[82:83], v[80:81]
  v_pk_add_f32 v[78:79], v[78:79], v[82:83]
  v_pk_add_f32 v[84:85], v[34:35], v[76:77] op_sel_hi:[1,0] neg_lo:[0,1] neg_hi:[0,1]
  v_pk_fma_f32 v[80:81], v[84:85], v[84:85], v[80:81]
  v_pk_add_f32 v[78:79], v[78:79], v[84:85]
  v_pk_add_f32 v[82:83], v[36:37], v[76:77] op_sel_hi:[1,0] neg_lo:[0,1] neg_hi:[0,1]
  v_pk_fma_f32 v[80:81], v[82:83], v[82:83], v[80:81]
  v_pk_add_f32 v[78:79], v[78:79], v[82:83]
  v_pk_add_f32 v[84:85], v[38:39], v[76:77] op_sel_hi:[1,0] neg_lo:[0,1] neg_hi:[0,1]
  v_pk_fma_f32 v[80:81], v[84:85], v[84:85], v[80:81]
  v_pk_add_f32 v[78:79], v[78:79], v[84:85]
  v_pk_add_f32 v[82:83], v[40:41], v[76:77] op_sel_hi:[1,0] neg_lo:[0,1] neg_hi:[0,1]
  v_pk_fma_f32 v[80:81], v[82:83], v[82:83], v[80:81]
  v_pk_add_f32 v[78:79], v[78:79], v[82:83]
  v_pk_add_f32 v[84:85], v[42:43], v[76:77] op_sel_hi:[1,0] neg_lo:[0,1] neg_hi:[0,1]
  v_pk_fma_f32 v[80:81], v[84:85], v[84:85], v[80:81]
  v_pk_add_f32 v[78:79], v[78:79], v[84:85]
  v_pk_add_f32 v[82:83], v[44:45], v[76:77] op_sel_hi:[1,0] neg_lo:[0,1] neg_hi:[0,1]
  v_pk_fma_f32 v[80:81], v[82:83], v[82:83], v[80:81]
  v_pk_add_f32 v[78:79], v[78:79], v[82:83]
  v_pk_add_f32 v[84:85], v[46:47], v[76:77] op_sel_hi:[1,0] neg_lo:[0,1] neg_hi:[0,1]
  v_pk_fma_f32 v[80:81], v[84:85], v[84:85], v[80:81]
  v_pk_add_f32 v[78:79], v[78:79], v[84:85]
  v_pk_add_f32 v[82:83], v[48:49], v[76:77] op_sel_hi:[1,0] neg_lo:[0,1] neg_hi:[0,1]
  v_pk_fma_f32 v[80:81], v[82:83], v[82:83], v[80:81]
  v_pk_add_f32 v[78:79], v[78:79], v[82:83]
  v_pk_add_f32 v[84:85], v[50:51], v[76:77] op_sel_hi:[1,0] neg_lo:[0,1] neg_hi:[0,1]
  v_pk_fma_f32 v[80:81], v[84:85], v[84:85], v[80:81]
  v_pk_add_f32 v[78:79], v[78:79], v[84:85]
  v_pk_add_f32 v[82:83], v[52:53], v[76:77] op_sel_hi:[1,0] neg_lo:[0,1] neg_hi:[0,1]
  v_pk_fma_f32 v[80:81], v[82:83], v[82:83], v[80:81]
  v_pk_add_f32 v[78:79], v[78:79], v[82:83]
  v_pk_add_f32 v[84:85], v[54:55], v[76:77] op_sel_hi:[1,0] neg_lo:[0,1] neg_hi:[0,1]
  v_pk_fma_f32 v[80:81], v[84:85], v[84:85], v[80:81]
  v_pk_add_f32 v[78:79], v[78:79], v[84:85]
  v_add_f32 v78, v78, v79
  v_add_f32 v80, v80, v81
  v_cndmask_b32 v78, 0, v78, s[60:61]
  v_cndmask_b32 v80, 0, v80, s[60:61]
  s_nop 0
  v_add_f32_dpp v78, v78, v78 row_ror:8 row_mask:0xf bank_mask:0xf
  v_add_f32_dpp v80, v80, v80 row_ror:8 row_mask:0xf bank_mask:0xf
  s_nop 0
  v_add_f32_dpp v78, v78, v78 row_ror:4 row_mask:0xf bank_mask:0xf
  v_add_f32_dpp v80, v80, v80 row_ror:4 row_mask:0xf bank_mask:0xf
  s_nop 0
  v_add_f32_dpp v78, v78, v78 row_ror:2 row_mask:0xf bank_mask:0xf
  v_add_f32_dpp v80, v80, v80 row_ror:2 row_mask:0xf bank_mask:0xf
  s_nop 0
  v_add_f32_dpp v78, v78, v78 row_ror:1 row_mask:0xf bank_mask:0xf
  v_add_f32_dpp v80, v80, v80 row_ror:1 row_mask:0xf bank_mask:0xf
  v_mul_f32 v78, s62, v78
  v_mul_f32 v84, v78, v78
  v_fma_f32 v80, v80, s62, -v84
  v_add_f32 v78, v76, v78
  v_max_f32 v80, 0, v80
  v_cvt_pk_bf16_f32 v85, 0, v80
  v_cvt_pk_bf16_f32 v86, 0, v78
  v_add_f32 v85, s63, v85
  v_cvt_pk_bf16_f32 v85, 0, v85
  v_sqrt_f32 v85, v85
  s_nop 0
  v_cvt_pk_bf16_f32 v85, 0, v85
  v_rcp_f32 v88, v85
  s_nop 0
  v_pk_add_f32 v[24:25], v[24:25], v[86:87] op_sel_hi:[1,0] neg_lo:[0,1] neg_hi:[0,1]
  v_pk_add_f32 v[26:27], v[26:27], v[86:87] op_sel_hi:[1,0] neg_lo:[0,1] neg_hi:[0,1]
  v_pk_add_f32 v[28:29], v[28:29], v[86:87] op_sel_hi:[1,0] neg_lo:[0,1] neg_hi:[0,1]
  v_pk_add_f32 v[30:31], v[30:31], v[86:87] op_sel_hi:[1,0] neg_lo:[0,1] neg_hi:[0,1]
  v_cvt_pk_bf16_f32 v24, 0, v24
  v_cvt_pk_bf16_f32 v25, 0, v25
  v_cvt_pk_bf16_f32 v26, 0, v26
  v_cvt_pk_bf16_f32 v27, 0, v27
  v_cvt_pk_bf16_f32 v28, 0, v28
  v_cvt_pk_bf16_f32 v29, 0, v29
  v_cvt_pk_bf16_f32 v30, 0, v30
  v_cvt_pk_bf16_f32 v31, 0, v31
  v_pk_mul_f32 v[24:25], v[24:25], v[88:89] op_sel_hi:[1,0]
  v_pk_mul_f32 v[26:27], v[26:27], v[88:89] op_sel_hi:[1,0]
  v_pk_mul_f32 v[28:29], v[28:29], v[88:89] op_sel_hi:[1,0]
  v_pk_mul_f32 v[30:31], v[30:31], v[88:89] op_sel_hi:[1,0]
  v_cvt_pk_bf16_f32 v8, v24, v25
  v_cvt_pk_bf16_f32 v9, v26, v27
  v_cvt_pk_bf16_f32 v10, v28, v29
  v_cvt_pk_bf16_f32 v11, v30, v31
  ds_write_b128 v57, v[8:11] offset:2048
  v_add_u32 v58, 2048, v58
  s_waitcnt lgkmcnt(0)
  ds_read2_b32 v[8:9], v58 offset0:0 offset1:1
  ds_read2_b32 v[10:11], v58 offset0:2 offset1:3
  ds_read2_b32 v[12:13], v58 offset0:4 offset1:5
  ds_read_b32 v14, v58 offset:24
  ds_read2_b32 v[16:17], v58 offset0:64 offset1:65
  ds_read2_b32 v[18:19], v58 offset0:66 offset1:67
  ds_read2_b32 v[20:21], v58 offset0:68 offset1:69
  ds_read_b32 v22, v58 offset:280
  ds_read2_b32 v[24:25], v58 offset0:128 offset1:129
  ds_read2_b32 v[26:27], v58 offset0:130 offset1:131
  ds_read2_b32 v[28:29], v58 offset0:132 offset1:133
  ds_read_b32 v30, v58 offset:536
  s_waitcnt lgkmcnt(8)
  ds_read2_b32 v[32:33], v58 offset0:192 offset1:193
  ds_read2_b32 v[34:35], v58 offset0:194 offset1:195
  ds_read2_b32 v[36:37], v58 offset0:196 offset1:197
  ds_read_b32 v38, v58 offset:792
  s_waitcnt lgkmcnt(0)
  s_load_dword s6, s[30:31], 0
  s_waitcnt vmcnt(12)
  v_perm_b32 v40, v104, v100, s64
  v_perm_b32 v41, v104, v100, s65
  v_perm_b32 v42, v105, v101, s64
  v_perm_b32 v43, v105, v101, s65
  v_perm_b32 v44, v106, v102, s64
  v_perm_b32 v45, v106, v102, s65
  v_perm_b32 v46, v107, v103, s64
  v_perm_b32 v47, v107, v103, s65
  v_dot2_f32_bf16 v60, v40, v8, 0
  v_dot2_f32_bf16 v61, v41, v8, 0
  v_dot2_f32_bf16 v62, v42, v8, 0
  v_dot2_f32_bf16 v63, v43, v8, 0
  v_dot2_f32_bf16 v64, v44, v8, 0
  v_dot2_f32_bf16 v65, v45, v8, 0
  v_dot2_f32_bf16 v66, v46, v8, 0
  v_dot2_f32_bf16 v67, v47, v8, 0
  v_dot2_f32_bf16 v68, v40, v16, 0
  v_dot2_f32_bf16 v69, v41, v16, 0
  v_dot2_f32_bf16 v70, v42, v16, 0
  v_dot2_f32_bf16 v71, v43, v16, 0
  v_dot2_f32_bf16 v72, v44, v16, 0
  v_dot2_f32_bf16 v73, v45, v16, 0
  v_dot2_f32_bf16 v74, v46, v16, 0
  v_dot2_f32_bf16 v75, v47, v16, 0
  v_dot2_f32_bf16 v76, v40, v24, 0
  v_dot2_f32_bf16 v77, v41, v24, 0
  v_dot2_f32_bf16 v78, v42, v24, 0
  v_dot2_f32_bf16 v79, v43, v24, 0
  v_dot2_f32_bf16 v80, v44, v24, 0
  v_dot2_f32_bf16 v81, v45, v24, 0
  v_dot2_f32_bf16 v82, v46, v24, 0
  v_dot2_f32_bf16 v83, v47, v24, 0
  v_dot2_f32_bf16 v84, v40, v32, 0
  v_dot2_f32_bf16 v85, v41, v32, 0
  v_dot2_f32_bf16 v86, v42, v32, 0
  v_dot2_f32_bf16 v87, v43, v32, 0
  v_dot2_f32_bf16 v88, v44, v32, 0
  v_dot2_f32_bf16 v89, v45, v32, 0
  v_dot2_f32_bf16 v90, v46, v32, 0
  v_dot2_f32_bf16 v91, v47, v32, 0
  s_waitcnt vmcnt(10)
  v_perm_b32 v40, v112, v108, s64
  v_perm_b32 v41, v112, v108, s65
  v_perm_b32 v42, v113, v109, s64
  v_perm_b32 v43, v113, v109, s65
  v_perm_b32 v44, v114, v110, s64
  v_perm_b32 v45, v114, v110, s65
  v_perm_b32 v46, v115, v111, s64
  v_perm_b32 v47, v115, v111, s65
  v_dot2_f32_bf16 v60, v40, v9, v60
  v_dot2_f32_bf16 v61, v41, v9, v61
  v_dot2_f32_bf16 v62, v42, v9, v62
  v_dot2_f32_bf16 v63, v43, v9, v63
  v_dot2_f32_bf16 v64, v44, v9, v64
  v_dot2_f32_bf16 v65, v45, v9, v65
  v_dot2_f32_bf16 v66, v46, v9, v66
  v_dot2_f32_bf16 v67, v47, v9, v67
  v_dot2_f32_bf16 v68, v40, v17, v68
  v_dot2_f32_bf16 v69, v41, v17, v69
  v_dot2_f32_bf16 v70, v42, v17, v70
  v_dot2_f32_bf16 v71, v43, v17, v71
  v_dot2_f32_bf16 v72, v44, v17, v72
  v_dot2_f32_bf16 v73, v45, v17, v73
  v_dot2_f32_bf16 v74, v46, v17, v74
  v_dot2_f32_bf16 v75, v47, v17, v75
  v_dot2_f32_bf16 v76, v40, v25, v76
  v_dot2_f32_bf16 v77, v41, v25, v77
  v_dot2_f32_bf16 v78, v42, v25, v78
  v_dot2_f32_bf16 v79, v43, v25, v79
  v_dot2_f32_bf16 v80, v44, v25, v80
  v_dot2_f32_bf16 v81, v45, v25, v81
  v_dot2_f32_bf16 v82, v46, v25, v82
  v_dot2_f32_bf16 v83, v47, v25, v83
  v_dot2_f32_bf16 v84, v40, v33, v84
  v_dot2_f32_bf16 v85, v41, v33, v85
  v_dot2_f32_bf16 v86, v42, v33, v86
  v_dot2_f32_bf16 v87, v43, v33, v87
  v_dot2_f32_bf16 v88, v44, v33, v88
  v_dot2_f32_bf16 v89, v45, v33, v89
  v_dot2_f32_bf16 v90, v46, v33, v90
  v_dot2_f32_bf16 v91, v47, v33, v91
  s_waitcnt vmcnt(8)
  v_perm_b32 v40, v120, v116, s64
  v_perm_b32 v41, v120, v116, s65
  v_perm_b32 v42, v121, v117, s64
  v_perm_b32 v43, v121, v117, s65
  v_perm_b32 v44, v122, v118, s64
  v_perm_b32 v45, v122, v118, s65
  v_perm_b32 v46, v123, v119, s64
  v_perm_b32 v47, v123, v119, s65
  v_dot2_f32_bf16 v60, v40, v10, v60
  v_dot2_f32_bf16 v61, v41, v10, v61
  v_dot2_f32_bf16 v62, v42, v10, v62
  v_dot2_f32_bf16 v63, v43, v10, v63
  v_dot2_f32_bf16 v64, v44, v10, v64
  v_dot2_f32_bf16 v65, v45, v10, v65
  v_dot2_f32_bf16 v66, v46, v10, v66
  v_dot2_f32_bf16 v67, v47, v10, v67
  v_dot2_f32_bf16 v68, v40, v18, v68
  v_dot2_f32_bf16 v69, v41, v18, v69
  v_dot2_f32_bf16 v70, v42, v18, v70
  v_dot2_f32_bf16 v71, v43, v18, v71
  v_dot2_f32_bf16 v72, v44, v18, v72
  v_dot2_f32_bf16 v73, v45, v18, v73
  v_dot2_f32_bf16 v74, v46, v18, v74
  v_dot2_f32_bf16 v75, v47, v18, v75
  v_dot2_f32_bf16 v76, v40, v26, v76
  v_dot2_f32_bf16 v77, v41, v26, v77
  v_dot2_f32_bf16 v78, v42, v26, v78
  v_dot2_f32_bf16 v79, v43, v26, v79
  v_dot2_f32_bf16 v80, v44, v26, v80
  v_dot2_f32_bf16 v81, v45, v26, v81
  v_dot2_f32_bf16 v82, v46, v26, v82
  v_dot2_f32_bf16 v83, v47, v26, v83
  v_dot2_f32_bf16 v84, v40, v34, v84
  v_dot2_f32_bf16 v85, v41, v34, v85
  v_dot2_f32_bf16 v86, v42, v34, v86
  v_dot2_f32_bf16 v87, v43, v34, v87
  v_dot2_f32_bf16 v88, v44, v34, v88
  v_dot2_f32_bf16 v89, v45, v34, v89
  v_dot2_f32_bf16 v90, v46, v34, v90
  v_dot2_f32_bf16 v91, v47, v34, v91
  s_waitcnt vmcnt(6)
  s_barrier
  v_perm_b32 v40, v128, v124, s64
  v_perm_b32 v41, v128, v124, s65
  v_perm_b32 v42, v129, v125, s64
  v_perm_b32 v43, v129, v125, s65
  v_perm_b32 v44, v130, v126, s64
  v_perm_b32 v45, v130, v126, s65
  v_perm_b32 v46, v131, v127, s64
  v_perm_b32 v47, v131, v127, s65
  v_dot2_f32_bf16 v60, v40, v11, v60
  v_dot2_f32_bf16 v61, v41, v11, v61
  v_dot2_f32_bf16 v62, v42, v11, v62
  v_dot2_f32_bf16 v63, v43, v11, v63
  v_dot2_f32_bf16 v64, v44, v11, v64
  v_dot2_f32_bf16 v65, v45, v11, v65
  v_dot2_f32_bf16 v66, v46, v11, v66
  v_dot2_f32_bf16 v67, v47, v11, v67
  v_dot2_f32_bf16 v68, v40, v19, v68
  v_dot2_f32_bf16 v69, v41, v19, v69
  v_dot2_f32_bf16 v70, v42, v19, v70
  v_dot2_f32_bf16 v71, v43, v19, v71
  v_dot2_f32_bf16 v72, v44, v19, v72
  v_dot2_f32_bf16 v73, v45, v19, v73
  v_dot2_f32_bf16 v74, v46, v19, v74
  v_dot2_f32_bf16 v75, v47, v19, v75
  v_dot2_f32_bf16 v76, v40, v27, v76
  v_dot2_f32_bf16 v77, v41, v27, v77
  v_dot2_f32_bf16 v78, v42, v27, v78
  v_dot2_f32_bf16 v79, v43, v27, v79
  v_dot2_f32_bf16 v80, v44, v27, v80
  v_dot2_f32_bf16 v81, v45, v27, v81
  v_dot2_f32_bf16 v82, v46, v27, v82
  v_dot2_f32_bf16 v83, v47, v27, v83
  v_dot2_f32_bf16 v84, v40, v35, v84
  v_dot2_f32_bf16 v85, v41, v35, v85
  v_dot2_f32_bf16 v86, v42, v35, v86
  v_dot2_f32_bf16 v87, v43, v35, v87
  v_dot2_f32_bf16 v88, v44, v35, v88
  v_dot2_f32_bf16 v89, v45, v35, v89
  v_dot2_f32_bf16 v90, v46, v35, v90
  v_dot2_f32_bf16 v91, v47, v35, v91
  s_waitcnt vmcnt(4)
  v_perm_b32 v40, v136, v132, s64
  v_perm_b32 v41, v136, v132, s65
  v_perm_b32 v42, v137, v133, s64
  v_perm_b32 v43, v137, v133, s65
  v_perm_b32 v44, v138, v134, s64
  v_perm_b32 v45, v138, v134, s65
  v_perm_b32 v46, v139, v135, s64
  v_perm_b32 v47, v139, v135, s65
  v_dot2_f32_bf16 v60, v40, v12, v60
  v_dot2_f32_bf16 v61, v41, v12, v61
  v_dot2_f32_bf16 v62, v42, v12, v62
  v_dot2_f32_bf16 v63, v43, v12, v63
  v_dot2_f32_bf16 v64, v44, v12, v64
  v_dot2_f32_bf16 v65, v45, v12, v65
  v_dot2_f32_bf16 v66, v46, v12, v66
  v_dot2_f32_bf16 v67, v47, v12, v67
  v_dot2_f32_bf16 v68, v40, v20, v68
  v_dot2_f32_bf16 v69, v41, v20, v69
  v_dot2_f32_bf16 v70, v42, v20, v70
  v_dot2_f32_bf16 v71, v43, v20, v71
  v_dot2_f32_bf16 v72, v44, v20, v72
  v_dot2_f32_bf16 v73, v45, v20, v73
  v_dot2_f32_bf16 v74, v46, v20, v74
  v_dot2_f32_bf16 v75, v47, v20, v75
  v_dot2_f32_bf16 v76, v40, v28, v76
  v_dot2_f32_bf16 v77, v41, v28, v77
  v_dot2_f32_bf16 v78, v42, v28, v78
  v_dot2_f32_bf16 v79, v43, v28, v79
  v_dot2_f32_bf16 v80, v44, v28, v80
  v_dot2_f32_bf16 v81, v45, v28, v81
  v_dot2_f32_bf16 v82, v46, v28, v82
  v_dot2_f32_bf16 v83, v47, v28, v83
  v_dot2_f32_bf16 v84, v40, v36, v84
  v_dot2_f32_bf16 v85, v41, v36, v85
  v_dot2_f32_bf16 v86, v42, v36, v86
  v_dot2_f32_bf16 v87, v43, v36, v87
  v_dot2_f32_bf16 v88, v44, v36, v88
  v_dot2_f32_bf16 v89, v45, v36, v89
  v_dot2_f32_bf16 v90, v46, v36, v90
  v_dot2_f32_bf16 v91, v47, v36, v91
  s_waitcnt vmcnt(2)
  v_perm_b32 v40, v144, v140, s64
  v_perm_b32 v41, v144, v140, s65
  v_perm_b32 v42, v145, v141, s64
  v_perm_b32 v43, v145, v141, s65
  v_perm_b32 v44, v146, v142, s64
  v_perm_b32 v45, v146, v142, s65
  v_perm_b32 v46, v147, v143, s64
  v_perm_b32 v47, v147, v143, s65
  v_dot2_f32_bf16 v60, v40, v13, v60
  v_dot2_f32_bf16 v61, v41, v13, v61
  v_dot2_f32_bf16 v62, v42, v13, v62
  v_dot2_f32_bf16 v63, v43, v13, v63
  v_dot2_f32_bf16 v64, v44, v13, v64
  v_dot2_f32_bf16 v65, v45, v13, v65
  v_dot2_f32_bf16 v66, v46, v13, v66
  v_dot2_f32_bf16 v67, v47, v13, v67
  v_dot2_f32_bf16 v68, v40, v21, v68
  v_dot2_f32_bf16 v69, v41, v21, v69
  v_dot2_f32_bf16 v70, v42, v21, v70
  v_dot2_f32_bf16 v71, v43, v21, v71
  v_dot2_f32_bf16 v72, v44, v21, v72
  v_dot2_f32_bf16 v73, v45, v21, v73
  v_dot2_f32_bf16 v74, v46, v21, v74
  v_dot2_f32_bf16 v75, v47, v21, v75
  v_dot2_f32_bf16 v76, v40, v29, v76
  v_dot2_f32_bf16 v77, v41, v29, v77
  v_dot2_f32_bf16 v78, v42, v29, v78
  v_dot2_f32_bf16 v79, v43, v29, v79
  v_dot2_f32_bf16 v80, v44, v29, v80
  v_dot2_f32_bf16 v81, v45, v29, v81
  v_dot2_f32_bf16 v82, v46, v29, v82
  v_dot2_f32_bf16 v83, v47, v29, v83
  v_dot2_f32_bf16 v84, v40, v37, v84
  v_dot2_f32_bf16 v85, v41, v37, v85
  v_dot2_f32_bf16 v86, v42, v37, v86
  v_dot2_f32_bf16 v87, v43, v37, v87
  v_dot2_f32_bf16 v88, v44, v37, v88
  v_dot2_f32_bf16 v89, v45, v37, v89
  v_dot2_f32_bf16 v90, v46, v37, v90
  v_dot2_f32_bf16 v91, v47, v37, v91
  s_waitcnt vmcnt(0)
  v_perm_b32 v40, v152, v148, s64
  v_perm_b32 v41, v152, v148, s65
  v_perm_b32 v42, v153, v149, s64
  v_perm_b32 v43, v153, v149, s65
  v_perm_b32 v44, v154, v150, s64
  v_perm_b32 v45, v154, v150, s65
  v_perm_b32 v46, v155, v151, s64
  v_perm_b32 v47, v155, v151, s65
  v_dot2_f32_bf16 v60, v40, v14, v60
  v_dot2_f32_bf16 v61, v41, v14, v61
  v_dot2_f32_bf16 v62, v42, v14, v62
  v_dot2_f32_bf16 v63, v43, v14, v63
  v_dot2_f32_bf16 v64, v44, v14, v64
  v_dot2_f32_bf16 v65, v45, v14, v65
  v_dot2_f32_bf16 v66, v46, v14, v66
  v_dot2_f32_bf16 v67, v47, v14, v67
  v_dot2_f32_bf16 v68, v40, v22, v68
  v_dot2_f32_bf16 v69, v41, v22, v69
  v_dot2_f32_bf16 v70, v42, v22, v70
  v_dot2_f32_bf16 v71, v43, v22, v71
  v_dot2_f32_bf16 v72, v44, v22, v72
  v_dot2_f32_bf16 v73, v45, v22, v73
  v_dot2_f32_bf16 v74, v46, v22, v74
  v_dot2_f32_bf16 v75, v47, v22, v75
  v_dot2_f32_bf16 v76, v40, v30, v76
  v_dot2_f32_bf16 v77, v41, v30, v77
  v_dot2_f32_bf16 v78, v42, v30, v78
  v_dot2_f32_bf16 v79, v43, v30, v79
  v_dot2_f32_bf16 v80, v44, v30, v80
  v_dot2_f32_bf16 v81, v45, v30, v81
  v_dot2_f32_bf16 v82, v46, v30, v82
  v_dot2_f32_bf16 v83, v47, v30, v83
  v_dot2_f32_bf16 v84, v40, v38, v84
  v_dot2_f32_bf16 v85, v41, v38, v85
  v_dot2_f32_bf16 v86, v42, v38, v86
  v_dot2_f32_bf16 v87, v43, v38, v87
  v_dot2_f32_bf16 v88, v44, v38, v88
  v_dot2_f32_bf16 v89, v45, v38, v89
  v_dot2_f32_bf16 v90, v46, v38, v90
  v_dot2_f32_bf16 v91, v47, v38, v91
  v_add_f32_dpp v60, v60, v60 row_ror:8 row_mask:0xf bank_mask:0x3
  v_add_f32_dpp v60, v64, v64 row_ror:8 row_mask:0xf bank_mask:0xc
  v_add_f32_dpp v61, v61, v61 row_ror:8 row_mask:0xf bank_mask:0x3
  v_add_f32_dpp v61, v65, v65 row_ror:8 row_mask:0xf bank_mask:0xc
  v_add_f32_dpp v62, v62, v62 row_ror:8 row_mask:0xf bank_mask:0x3
  v_add_f32_dpp v62, v66, v66 row_ror:8 row_mask:0xf bank_mask:0xc
  v_add_f32_dpp v63, v63, v63 row_ror:8 row_mask:0xf bank_mask:0x3
  v_add_f32_dpp v63, v67, v67 row_ror:8 row_mask:0xf bank_mask:0xc
  v_add_f32_dpp v68, v68, v68 row_ror:8 row_mask:0xf bank_mask:0x3
  v_add_f32_dpp v68, v72, v72 row_ror:8 row_mask:0xf bank_mask:0xc
  v_add_f32_dpp v69, v69, v69 row_ror:8 row_mask:0xf bank_mask:0x3
  v_add_f32_dpp v69, v73, v73 row_ror:8 row_mask:0xf bank_mask:0xc
  v_add_f32_dpp v70, v70, v70 row_ror:8 row_mask:0xf bank_mask:0x3
  v_add_f32_dpp v70, v74, v74 row_ror:8 row_mask:0xf bank_mask:0xc
  v_add_f32_dpp v71, v71, v71 row_ror:8 row_mask:0xf bank_mask:0x3
  v_add_f32_dpp v71, v75, v75 row_ror:8 row_mask:0xf bank_mask:0xc
  v_add_f32_dpp v76, v76, v76 row_ror:8 row_mask:0xf bank_mask:0x3
  v_add_f32_dpp v76, v80, v80 row_ror:8 row_mask:0xf bank_mask:0xc
  v_add_f32_dpp v77, v77, v77 row_ror:8 row_mask:0xf bank_mask:0x3
  v_add_f32_dpp v77, v81, v81 row_ror:8 row_mask:0xf bank_mask:0xc
  v_add_f32_dpp v78, v78, v78 row_ror:8 row_mask:0xf bank_mask:0x3
  v_add_f32_dpp v78, v82, v82 row_ror:8 row_mask:0xf bank_mask:0xc
  v_add_f32_dpp v79, v79, v79 row_ror:8 row_mask:0xf bank_mask:0x3
  v_add_f32_dpp v79, v83, v83 row_ror:8 row_mask:0xf bank_mask:0xc
  v_add_f32_dpp v84, v84, v84 row_ror:8 row_mask:0xf bank_mask:0x3
  v_add_f32_dpp v84, v88, v88 row_ror:8 row_mask:0xf bank_mask:0xc
  v_add_f32_dpp v85, v85, v85 row_ror:8 row_mask:0xf bank_mask:0x3
  v_add_f32_dpp v85, v89, v89 row_ror:8 row_mask:0xf bank_mask:0xc
  v_add_f32_dpp v86, v86, v86 row_ror:8 row_mask:0xf bank_mask:0x3
  v_add_f32_dpp v86, v90, v90 row_ror:8 row_mask:0xf bank_mask:0xc
  v_add_f32_dpp v87, v87, v87 row_ror:8 row_mask:0xf bank_mask:0x3
  v_add_f32_dpp v87, v91, v91 row_ror:8 row_mask:0xf bank_mask:0xc
  v_permlane16_swap_b32 v60, v68
  v_permlane16_swap_b32 v61, v69
  v_permlane16_swap_b32 v62, v70
  v_permlane16_swap_b32 v63, v71
  v_permlane16_swap_b32 v76, v84
  v_permlane16_swap_b32 v77, v85
  v_permlane16_swap_b32 v78, v86
  v_permlane16_swap_b32 v79, v87
  v_add_f32 v60, v60, v68
  v_add_f32 v61, v61, v69
  v_add_f32 v62, v62, v70
  v_add_f32 v63, v63, v71
  v_add_f32 v76, v76, v84
  v_add_f32 v77, v77, v85
  v_add_f32 v78, v78, v86
  v_add_f32 v79, v79, v87
  v_permlane32_swap_b32 v60, v76
  v_permlane32_swap_b32 v61, v77
  v_permlane32_swap_b32 v62, v78
  v_permlane32_swap_b32 v63, v79
  v_add_f32 v60, v60, v76
  v_add_f32 v61, v61, v77
  v_add_f32 v62, v62, v78
  v_add_f32 v63, v63, v79
  ds_write_b128 v57, v[60:63] offset:10752
  s_branch L_hn1
L_hnp:
  s_waitcnt lgkmcnt(0)
  s_mov_b32 s35, s98
  s_cmp_eq_u32 s34, 0
  s_cbranch_scc1 L_he0
  s_cmp_eq_u32 s34, 1
  s_cbranch_scc1 L_he1
  v_lshlrev_b32 v2, 4, v1
  v_lshlrev_b32 v3, 3, v1
  global_load_dwordx4 v[160:163], v2, s[20:21] offset:0
  global_load_dwordx4 v[164:167], v2, s[20:21] offset:1024
  global_load_dwordx4 v[168:171], v2, s[20:21] offset:2048
  global_load_dwordx2 v[172:173], v3, s[20:21] offset:3072
  global_load_dwordx4 v[176:179], v2, s[22:23] offset:0
  global_load_dwordx4 v[180:183], v2, s[22:23] offset:1024
  global_load_dwordx4 v[184:187], v2, s[22:23] offset:2048
  global_load_dwordx2 v[188:189], v3, s[22:23] offset:3072
  global_load_dwordx4 v[120:123], v2, s[24:25] offset:0
  global_load_dwordx4 v[124:127], v2, s[24:25] offset:1024
  global_load_dwordx4 v[128:131], v2, s[24:25] offset:2048
  global_load_dwordx2 v[132:133], v3, s[24:25] offset:3072
  s_branch L_he1
L_he0:
  s_lshr_b32 s40, s2, 3
  s_bfe_u32 s42, s2, 0x10002
  s_and_b32 s41, s2, 1
  s_lshl1_add_u32 s41, s42, s41
  s_sub_u32 s42, s40, s41
  s_and_b32 s43, s42, 7
  s_cmp_eq_u32 s43, 0
  s_cbranch_scc1 L_he1
  s_add_u32 s42, s42, 7
  s_lshr_b32 s42, s42, 3
  s_sub_u32 s40, s40, s42
  s_mul_i32 s41, s40, 37
  s_lshr_b32 s41, s41, 8
  s_mul_i32 s42, s41, 7
  s_sub_u32 s42, s40, s42
  s_and_b32 s40, s2, 7
  s_lshl2_add_u32 s40, s40, s41
  s_mul_i32 s43, s42, 293
  s_lshr_b32 s43, s43, 6
  s_mul_i32 s44, s40, 114688
  s_lshl_b32 s45, s42, 7
  s_add_u32 s44, s44, s45
  s_add_u32 s36, s16, s44
  s_addc_u32 s37, s17, 0
  s_sub_u32 s38, 114688, s45
  s_mov_b32 s39, 0x20000
  v_lshrrev_b32 v2, 3, v1
  v_and_b32 v3, 7, v1
  v_mul_u32_u24 v8, 144, v2
  v_lshl_add_u32 v8, v3, 4, v8
  v_mul_u32_u24 v2, 896, v2
  v_lshl_add_u32 v2, v3, 4, v2
  s_mov_b32 s44, 0
  buffer_load_dwordx4 v[160:163], v2, s[36:39], s44 offen nt
  s_add_u32 s44, s44, 7168
  buffer_load_dwordx4 v[164:167], v2, s[36:39], s44 offen nt
  s_add_u32 s44, s44, 7168
  buffer_load_dwordx4 v[168:171], v2, s[36:39], s44 offen nt
  s_add_u32 s44, s44, 7168
  buffer_load_dwordx4 v[172:175], v2, s[36:39], s44 offen nt
  s_add_u32 s44, s44, 7168
  buffer_load_dwordx4 v[176:179], v2, s[36:39], s44 offen nt
  s_add_u32 s44, s44, 7168
  buffer_load_dwordx4 v[180:183], v2, s[36:39], s44 offen nt
  s_add_u32 s44, s44, 7168
  buffer_load_dwordx4 v[184:187], v2, s[36:39], s44 offen nt
  s_add_u32 s44, s44, 7168
  buffer_load_dwordx4 v[188:191], v2, s[36:39], s44 offen nt
  s_add_u32 s44, s44, 7168
  buffer_load_dwordx4 v[192:195], v2, s[36:39], s44 offen nt
  s_add_u32 s44, s44, 7168
  buffer_load_dwordx4 v[196:199], v2, s[36:39], s44 offen nt
  s_add_u32 s44, s44, 7168
  buffer_load_dwordx4 v[200:203], v2, s[36:39], s44 offen nt
  s_add_u32 s44, s44, 7168
  buffer_load_dwordx4 v[204:207], v2, s[36:39], s44 offen nt
  s_add_u32 s44, s44, 7168
  buffer_load_dwordx4 v[208:211], v2, s[36:39], s44 offen nt
  s_add_u32 s44, s44, 7168
  buffer_load_dwordx4 v[212:215], v2, s[36:39], s44 offen nt
  s_add_u32 s44, s44, 7168
  buffer_load_dwordx4 v[216:219], v2, s[36:39], s44 offen nt
  s_add_u32 s44, s44, 7168
  buffer_load_dwordx4 v[220:223], v2, s[36:39], s44 offen nt
  s_add_u32 s44, s44, 7168
  v_lshlrev_b32 v3, 4, v1
  v_mov_b32 v224, 0
  v_mov_b32 v225, 0
  v_mov_b32 v226, 0
  v_mov_b32 v227, 0
  ds_write_b128 v3, v[224:227] offset:52480
  ds_write_b128 v3, v[224:227] offset:53504
  ds_write_b128 v3, v[224:227] offset:54528
  s_waitcnt vmcnt(15)
  ds_write_b128 v8, v[160:163] offset:34048
  s_waitcnt vmcnt(14)
  ds_write_b128 v8, v[164:167] offset:35200
  s_waitcnt vmcnt(13)
  ds_write_b128 v8, v[168:171] offset:36352
  s_waitcnt vmcnt(12)
  ds_write_b128 v8, v[172:175] offset:37504
  s_waitcnt vmcnt(11)
  ds_write_b128 v8, v[176:179] offset:38656
  s_waitcnt vmcnt(10)
  ds_write_b128 v8, v[180:183] offset:39808
  s_waitcnt vmcnt(9)
  ds_write_b128 v8, v[184:187] offset:40960
  s_waitcnt vmcnt(8)
  ds_write_b128 v8, v[188:191] offset:42112
  s_waitcnt vmcnt(7)
  ds_write_b128 v8, v[192:195] offset:43264
  s_waitcnt vmcnt(6)
  ds_write_b128 v8, v[196:199] offset:44416
  s_waitcnt vmcnt(5)
  ds_write_b128 v8, v[200:203] offset:45568
  s_waitcnt vmcnt(4)
  ds_write_b128 v8, v[204:207] offset:46720
  s_waitcnt vmcnt(3)
  ds_write_b128 v8, v[208:211] offset:47872
  s_waitcnt vmcnt(2)
  ds_write_b128 v8, v[212:215] offset:49024
  s_waitcnt vmcnt(1)
  ds_write_b128 v8, v[216:219] offset:50176
  s_waitcnt vmcnt(0)
  ds_write_b128 v8, v[220:223] offset:51328
L_he1:
  s_sleep 16
  s_load_dword s6, s[30:31], 0
L_hn1:
  s_waitcnt lgkmcnt(0)
  s_and_b32 s18, s6, 0x3fff
  s_lshr_b32 s19, s6, 2
  s_and_b32 s19, s19, 0x0fffc000
  s_or_b32 s18, s18, s19
  s_sub_u32 s18, s18, s35
  s_add_u32 s18, s18, 1500
  s_bfe_u32 s18, s18, 0x1001b
  s_bfe_u32 s19, s6, 0x1000f
  s_cmp_gt_u32 s19, s18
  s_cbranch_scc1 L_hnok
  s_sleep 4
  s_load_dword s6, s[30:31], 64
  s_waitcnt lgkmcnt(0)
  s_and_b32 s18, s6, 0x3fff
  s_lshr_b32 s19, s6, 2
  s_and_b32 s19, s19, 0x0fffc000
  s_or_b32 s18, s18, s19
  s_sub_u32 s18, s18, s35
  s_add_u32 s18, s18, 1500
  s_bfe_u32 s18, s18, 0x1001b
  s_bfe_u32 s19, s6, 0x1000f
  s_cmp_gt_u32 s19, s18
  s_cbranch_scc1 L_hnok
  s_sleep 4
  s_load_dword s6, s[30:31], 128
  s_waitcnt lgkmcnt(0)
  s_and_b32 s18, s6, 0x3fff
  s_lshr_b32 s19, s6, 2
  s_and_b32 s19, s19, 0x0fffc000
  s_or_b32 s18, s18, s19
  s_sub_u32 s18, s18, s35
  s_add_u32 s18, s18, 1500
  s_bfe_u32 s18, s18, 0x1001b
  s_bfe_u32 s19, s6, 0x1000f
  s_cmp_gt_u32 s19, s18
  s_cbranch_scc1 L_hnok
  s_mov_b32 s7, 262144
  v_mov_b32 v58, 0
L_hnw:
  global_load_dword v59, v58, s[30:31] sc1
  s_sub_u32 s7, s7, 1
  s_cbranch_scc1 L_exit
  s_waitcnt vmcnt(0)
  v_readfirstlane_b32 s6, v59
  s_nop 0
  s_and_b32 s18, s6, 0x3fff
  s_lshr_b32 s19, s6, 2
  s_and_b32 s19, s19, 0x0fffc000
  s_or_b32 s18, s18, s19
  s_sub_u32 s18, s18, s35
  s_add_u32 s18, s18, 1500
  s_bfe_u32 s18, s18, 0x1001b
  s_bfe_u32 s19, s6, 0x1000f
  s_cmp_gt_u32 s19, s18
  s_cbranch_scc1 L_hnok
  s_cmp_gt_u32 s7, 261944
  s_cbranch_scc1 L_hnw
  s_cmp_eq_u32 s6, 0
  s_cbranch_scc1 L_hnw
  s_branch L_hnok
L_hnok:
  s_lshl_b32 s18, s34, 2
  v_mov_b32 v58, s18
  v_mov_b32 v59, s6
  ds_write_b32 v58, v59 offset:0
  s_and_b32 s35, s4, 15
  s_lshl_b32 s35, s35, 2
  s_lshr_b32 s7, s4, 4
  s_add_u32 s35, s35, s7
  s_lshl_b32 s35, s35, 10
  s_lshl_b32 s7, s34, 8
  s_add_u32 s35, s35, s7
  s_add_u32 s100, s32, s35
  s_addc_u32 s101, s33, 0
  s_cmp_lg_u32 s34, 0
  s_cbranch_scc1 L_hq
  v_mov_b32 v58, 0
  ds_write_b32 v58, v58 offset:16
  s_cmp_eq_u32 s5, 0
  s_cbranch_scc1 L_hq
  v_mov_b32 v58, 0
  v_lshlrev_b32 v57, 4, v1
  s_lshr_b32 s18, s4, 2
  s_lshl_b32 s18, s18, 12
  s_and_b32 s19, s4, 3
  s_lshl_b32 s19, s19, 8
  s_add_u32 s18, s18, s19
  v_lshrrev_b32 v8, 4, v1
  v_lshlrev_b32 v8, 10, v8
  v_and_b32 v9, 7, v1
  v_lshl_add_u32 v8, v9, 5, v8
  v_bfe_u32 v9, v1, 3, 1
  v_lshl_add_u32 v8, v9, 4, v8
  v_add_u32 v8, s18, v8
  v_mov_b32 v34, s6
  v_mov_b32 v35, s6
  s_mov_b32 s19, 262144
L_hfw:
  ds_read_b128 v[12:15], v58 offset:0
  ds_read_b128 v[16:19], v57 offset:10752
  ds_read_b128 v[20:23], v57 offset:11776
  ds_read_b128 v[24:27], v57 offset:12800
  ds_read_b128 v[28:31], v57 offset:13824
  s_sub_u32 s19, s19, 1
  s_cbranch_scc1 L_exit
  s_waitcnt lgkmcnt(0)
  v_xor_b32 v12, s6, v12
  v_bitop3_b32 v12, v13, s6, v12 bitop3:0xbe
  v_bitop3_b32 v12, v14, s6, v12 bitop3:0xbe
  v_bitop3_b32 v12, v15, s6, v12 bitop3:0xbe
  v_cmp_eq_u32 vcc, 0, v12
  s_cbranch_vccz L_hfw
  v_pk_add_f32 v[16:17], v[16:17], v[20:21]
  v_pk_add_f32 v[18:19], v[18:19], v[22:23]
  v_pk_add_f32 v[24:25], v[24:25], v[28:29]
  v_pk_add_f32 v[26:27], v[26:27], v[30:31]
  v_pk_add_f32 v[16:17], v[16:17], v[24:25]
  v_pk_add_f32 v[18:19], v[18:19], v[26:27]
  v_cvt_pk_bf16_f32 v32, v16, v17
  v_cvt_pk_bf16_f32 v33, v18, v19
  global_store_dwordx4 v8, v[32:35], s[32:33] sc1
L_hq:
  s_cmp_lg_u32 s5, 0
  s_cbranch_scc1 L_hq0
  s_cmp_eq_u32 s34, 0
  s_cbranch_scc1 L_hq0
  s_sleep 64
L_hq0:
  s_mov_b32 s19, 262144
L_hqw:
  s_load_dwordx16 s[36:51], s[100:101], 0 glc
  s_load_dwordx16 s[52:67], s[100:101], 64 glc
  s_load_dwordx16 s[68:83], s[100:101], 128 glc
  s_load_dwordx16 s[84:99], s[100:101], 192 glc
  s_sub_u32 s19, s19, 1
  s_cbranch_scc1 L_exit
  s_waitcnt lgkmcnt(0)
  s_xor_b32 s7, s38, s6
  s_xor_b32 s18, s42, s6
  s_or_b32 s7, s7, s18
  s_xor_b32 s18, s46, s6
  s_or_b32 s7, s7, s18
  s_xor_b32 s18, s50, s6
  s_or_b32 s7, s7, s18
  s_xor_b32 s18, s54, s6
  s_or_b32 s7, s7, s18
  s_xor_b32 s18, s58, s6
  s_or_b32 s7, s7, s18
  s_xor_b32 s18, s62, s6
  s_or_b32 s7, s7, s18
  s_xor_b32 s18, s66, s6
  s_or_b32 s7, s7, s18
  s_xor_b32 s18, s70, s6
  s_or_b32 s7, s7, s18
  s_xor_b32 s18, s74, s6
  s_or_b32 s7, s7, s18
  s_xor_b32 s18, s78, s6
  s_or_b32 s7, s7, s18
  s_xor_b32 s18, s82, s6
  s_or_b32 s7, s7, s18
  s_xor_b32 s18, s86, s6
  s_or_b32 s7, s7, s18
  s_xor_b32 s18, s90, s6
  s_or_b32 s7, s7, s18
  s_xor_b32 s18, s94, s6
  s_or_b32 s7, s7, s18
  s_xor_b32 s18, s98, s6
  s_or_b32 s7, s7, s18
  s_cbranch_scc0 L_hqok
  s_sleep 1
  s_branch L_hqw
L_hqok:
  v_writelane_b32 v8, s36, 0
  v_writelane_b32 v8, s37, 1
  v_writelane_b32 v8, s40, 2
  v_writelane_b32 v8, s41, 3
  v_writelane_b32 v8, s44, 4
  v_writelane_b32 v8, s45, 5
  v_writelane_b32 v8, s48, 6
  v_writelane_b32 v8, s49, 7
  v_writelane_b32 v8, s52, 8
  v_writelane_b32 v8, s53, 9
  v_writelane_b32 v8, s56, 10
  v_writelane_b32 v8, s57, 11
  v_writelane_b32 v8, s60, 12
  v_writelane_b32 v8, s61, 13
  v_writelane_b32 v8, s64, 14
  v_writelane_b32 v8, s65, 15
  v_writelane_b32 v8, s68, 16
  v_writelane_b32 v8, s69, 17
  v_writelane_b32 v8, s72, 18
  v_writelane_b32 v8, s73, 19
  v_writelane_b32 v8, s76, 20
  v_writelane_b32 v8, s77, 21
  v_writelane_b32 v8, s80, 22
  v_writelane_b32 v8, s81, 23
  v_writelane_b32 v8, s84, 24
  v_writelane_b32 v8, s85, 25
  v_writelane_b32 v8, s88, 26
  v_writelane_b32 v8, s89, 27
  v_writelane_b32 v8, s92, 28
  v_writelane_b32 v8, s93, 29
  v_writelane_b32 v8, s96, 30
  v_writelane_b32 v8, s97, 31
  s_lshl_b32 s18, s34, 7
  v_lshl_add_u32 v9, v1, 2, s18
  s_mov_b32 exec_hi, 0
  ds_write_b32 v9, v8 offset:64
  s_mov_b64 exec, -1
  s_load_dword s74, s[26:27], 0
  s_lshl_b32 s18, s34, 2
  v_mov_b32 v9, s18
  v_mov_b32 v8, s6
  s_waitcnt lgkmcnt(0)
  ds_write_b32 v9, v8 offset:576
  s_setprio 0
  s_bfe_u32 s19, s2, 0x10002
  s_and_b32 s18, s2, 1
  s_lshl1_add_u32 s18, s19, s18
  s_lshl2_add_u32 s18, s18, s34
  s_cmp_lg_u32 s18, 1
  s_cbranch_scc1 L_htk
  s_lshl_b32 s18, s4, 8
  s_add_u32 s18, s18, 344064
  v_mov_b32 v10, s18
  v_mov_b32 v8, 0
  v_mov_b32 v9, s6
  s_mov_b64 exec, 1
  global_store_dwordx2 v10, v[8:9], s[32:33] sc1
  s_mov_b64 exec, -1
L_htk:
  s_cmp_lt_u32 s34, 2
  s_cbranch_scc1 L_work
  s_sub_u32 s18, s2, 4
  s_mul_i32 s35, s18, 964
  s_lshr_b32 s35, s35, 16
  s_mul_i32 s19, s35, 68
  s_cmp_eq_u32 s18, s19
  s_cselect_b32 s35, s35, 4
  s_cmp_eq_u32 s34, 3
  s_cselect_b32 s35, s35, 4
L_hw:
  s_cmp_eq_u32 s5, 0
  s_cbranch_scc1 L_hw2
  v_lshlrev_b32 v2, 4, v1
  v_lshlrev_b32 v3, 3, v1
  global_load_dwordx4 v[160:163], v2, s[20:21] offset:0
  global_load_dwordx4 v[164:167], v2, s[20:21] offset:1024
  global_load_dwordx4 v[168:171], v2, s[20:21] offset:2048
  global_load_dwordx2 v[172:173], v3, s[20:21] offset:3072
  global_load_dwordx4 v[176:179], v2, s[22:23] offset:0
  global_load_dwordx4 v[180:183], v2, s[22:23] offset:1024
  global_load_dwordx4 v[184:187], v2, s[22:23] offset:2048
  global_load_dwordx2 v[188:189], v3, s[22:23] offset:3072
  global_load_dwordx4 v[120:123], v2, s[24:25] offset:0
  global_load_dwordx4 v[124:127], v2, s[24:25] offset:1024
  global_load_dwordx4 v[128:131], v2, s[24:25] offset:2048
  global_load_dwordx2 v[132:133], v3, s[24:25] offset:3072
L_hw2:
  v_mov_b32 v134, 0xc0135761
  v_mov_b32 v135, 0xc0135761
  s_mov_b32 s72, 0xbdd2d3e8
  s_mov_b32 s73, s72
  s_lshl_b32 s74, s74, 16
  s_waitcnt vmcnt(0)
  v_lshlrev_b32 v64, 16, v160
  v_and_b32 v65, 0xffff0000, v160
  v_lshlrev_b32 v92, 16, v176
  v_and_b32 v93, 0xffff0000, v176
  v_lshlrev_b32 v66, 16, v161
  v_and_b32 v67, 0xffff0000, v161
  v_lshlrev_b32 v94, 16, v177
  v_and_b32 v95, 0xffff0000, v177
  v_lshlrev_b32 v68, 16, v162
  v_and_b32 v69, 0xffff0000, v162
  v_lshlrev_b32 v96, 16, v178
  v_and_b32 v97, 0xffff0000, v178
  v_lshlrev_b32 v70, 16, v163
  v_and_b32 v71, 0xffff0000, v163
  v_lshlrev_b32 v98, 16, v179
  v_and_b32 v99, 0xffff0000, v179
  v_lshlrev_b32 v72, 16, v164
  v_and_b32 v73, 0xffff0000, v164
  v_lshlrev_b32 v100, 16, v180
  v_and_b32 v101, 0xffff0000, v180
  v_lshlrev_b32 v74, 16, v165
  v_and_b32 v75, 0xffff0000, v165
  v_lshlrev_b32 v102, 16, v181
  v_and_b32 v103, 0xffff0000, v181
  v_lshlrev_b32 v76, 16, v166
  v_and_b32 v77, 0xffff0000, v166
  v_lshlrev_b32 v104, 16, v182
  v_and_b32 v105, 0xffff0000, v182
  v_lshlrev_b32 v78, 16, v167
  v_and_b32 v79, 0xffff0000, v167
  v_lshlrev_b32 v106, 16, v183
  v_and_b32 v107, 0xffff0000, v183
  v_lshlrev_b32 v80, 16, v168
  v_and_b32 v81, 0xffff0000, v168
  v_lshlrev_b32 v108, 16, v184
  v_and_b32 v109, 0xffff0000, v184
  v_lshlrev_b32 v82, 16, v169
  v_and_b32 v83, 0xffff0000, v169
  v_lshlrev_b32 v110, 16, v185
  v_and_b32 v111, 0xffff0000, v185
  v_lshlrev_b32 v84, 16, v170
  v_and_b32 v85, 0xffff0000, v170
  v_lshlrev_b32 v112, 16, v186
  v_and_b32 v113, 0xffff0000, v186
  v_lshlrev_b32 v86, 16, v171
  v_and_b32 v87, 0xffff0000, v171
  v_lshlrev_b32 v114, 16, v187
  v_and_b32 v115, 0xffff0000, v187
  v_lshlrev_b32 v88, 16, v172
  v_and_b32 v89, 0xffff0000, v172
  v_lshlrev_b32 v116, 16, v188
  v_and_b32 v117, 0xffff0000, v188
  v_lshlrev_b32 v90, 16, v173
  v_and_b32 v91, 0xffff0000, v173
  v_lshlrev_b32 v118, 16, v189
  v_and_b32 v119, 0xffff0000, v189
  s_lshl_b32 s40, s2, 2
  s_lshl1_add_u32 s40, s34, s40
  s_sub_u32 s40, s40, 4
  s_add_u32 s50, s40, 2
L_tb:
  s_mul_i32 s41, s40, 6
  s_cmp_ge_u32 s41, 3072
  s_mov_b32 s43, 13824
  s_cselect_b32 s42, 43520, s43
  s_add_u32 s41, s41, s42
  s_add_u32 s70, s41, 0
  s_lshl_b32 s70, s70, 16
  s_mov_b32 s71, s70
  s_call_b64 s[76:77], L_eval
  s_nop 0
  v_readfirstlane_b32 s44, v153
  s_add_u32 s70, s41, 1
  s_lshl_b32 s70, s70, 16
  s_mov_b32 s71, s70
  s_call_b64 s[76:77], L_eval
  s_nop 0
  v_readfirstlane_b32 s45, v153
  s_add_u32 s70, s41, 2
  s_lshl_b32 s70, s70, 16
  s_mov_b32 s71, s70
  s_call_b64 s[76:77], L_eval
  s_nop 0
  v_readfirstlane_b32 s46, v153
  s_add_u32 s70, s41, 3
  s_lshl_b32 s70, s70, 16
  s_mov_b32 s71, s70
  s_call_b64 s[76:77], L_eval
  s_nop 0
  v_readfirstlane_b32 s47, v153
  s_add_u32 s70, s41, 4
  s_lshl_b32 s70, s70, 16
  s_mov_b32 s71, s70
  s_call_b64 s[76:77], L_eval
  s_nop 0
  v_readfirstlane_b32 s48, v153
  s_add_u32 s70, s41, 5
  s_lshl_b32 s70, s70, 16
  s_mov_b32 s71, s70
  s_call_b64 s[76:77], L_eval
  s_nop 0
  v_readfirstlane_b32 s49, v153
  s_nop 0
  s_pack_ll_b32_b16 s44, s44, s45
  s_pack_ll_b32_b16 s45, s46, s47
  s_pack_ll_b32_b16 s46, s48, s49
  s_lshl_b32 s41, s40, 4
  s_add_u32 s41, s41, 327680
  v_mov_b32 v8, s44
  v_mov_b32 v9, s45
  v_mov_b32 v10, s46
  v_mov_b32 v11, s6
  v_mov_b32 v12, s41
  s_mov_b64 exec, 1
  global_store_dwordx4 v12, v[8:11], s[32:33] sc1
  s_mov_b64 exec, -1
  s_add_u32 s40, s40, 1
  s_cmp_lt_u32 s40, s50
  s_cbranch_scc1 L_tb
  s_cmp_lt_u32 s35, 4
  s_cbranch_scc1 L_cons
  s_endpgm
L_work:
  s_lshr_b32 s40, s2, 3
  s_bfe_u32 s42, s2, 0x10002
  s_and_b32 s41, s2, 1
  s_lshl1_add_u32 s41, s42, s41
  s_sub_u32 s42, s40, s41
  s_and_b32 s43, s42, 7
  s_cmp_eq_u32 s43, 0
  s_cbranch_scc1 L_widle
  s_add_u32 s42, s42, 7
  s_lshr_b32 s42, s42, 3
  s_sub_u32 s40, s40, s42
  s_mul_i32 s41, s40, 37
  s_lshr_b32 s41, s41, 8
  s_mul_i32 s42, s41, 7
  s_sub_u32 s42, s40, s42
  s_and_b32 s40, s2, 7
  s_lshl2_add_u32 s40, s40, s41
  s_mul_i32 s43, s42, 293
  s_lshr_b32 s43, s43, 6
  v_lshrrev_b32 v5, 4, v1
  v_and_b32 v14, 15, v1
  v_mov_b32 v64, 0
  v_mov_b32 v65, 0
  v_mov_b32 v66, 0
  v_mov_b32 v67, 0
  v_mov_b32 v68, 0
  v_mov_b32 v69, 0
  v_mov_b32 v70, 0
  v_mov_b32 v71, 0
  v_mov_b32 v72, 0
  v_mov_b32 v73, 0
  v_mov_b32 v74, 0
  v_mov_b32 v75, 0
  v_mov_b32 v76, 0
  v_mov_b32 v77, 0
  v_mov_b32 v78, 0
  v_mov_b32 v79, 0
  v_mov_b32 v80, 0
  v_mov_b32 v81, 0
  v_mov_b32 v82, 0
  v_mov_b32 v83, 0
  v_mov_b32 v84, 0
  v_mov_b32 v85, 0
  v_mov_b32 v86, 0
  v_mov_b32 v87, 0
  v_mov_b32 v88, 0
  v_mov_b32 v89, 0
  v_mov_b32 v90, 0
  v_mov_b32 v91, 0
  v_mov_b32 v92, 0
  v_mov_b32 v93, 0
  v_mov_b32 v94, 0
  v_mov_b32 v95, 0
  v_mov_b32 v96, 0
  v_mov_b32 v97, 0
  v_mov_b32 v98, 0
  v_mov_b32 v99, 0
  v_mov_b32 v100, 0
  v_mov_b32 v101, 0
  v_mov_b32 v102, 0
  v_mov_b32 v103, 0
  v_mov_b32 v104, 0
  v_mov_b32 v105, 0
  v_mov_b32 v106, 0
  v_mov_b32 v107, 0
  v_mov_b32 v108, 0
  v_mov_b32 v109, 0
  v_mov_b32 v110, 0
  v_mov_b32 v111, 0
  v_mov_b32 v112, 0
  v_mov_b32 v113, 0
  v_mov_b32 v114, 0
  v_mov_b32 v115, 0
  v_mov_b32 v116, 0
  v_mov_b32 v117, 0
  v_mov_b32 v118, 0
  v_mov_b32 v119, 0
  v_mov_b32 v120, 0
  v_mov_b32 v121, 0
  v_mov_b32 v122, 0
  v_mov_b32 v123, 0
  v_mov_b32 v124, 0
  v_mov_b32 v125, 0
  v_mov_b32 v126, 0
  v_mov_b32 v127, 0
  v_mov_b32 v128, 0
  v_mov_b32 v129, 0
  v_mov_b32 v130, 0
  v_mov_b32 v131, 0
  v_mov_b32 v132, 0
  v_mov_b32 v133, 0
  v_mov_b32 v134, 0
  v_mov_b32 v135, 0
  s_cmp_lg_u32 s34, 0
  s_cbranch_scc1 L_wst
  s_cmp_eq_u32 s5, 0
  s_cbranch_scc1 L_wfl
  s_mul_i32 s44, s40, 114688
  s_lshl_b32 s45, s42, 7
  s_add_u32 s44, s44, s45
  s_add_u32 s36, s16, s44
  s_addc_u32 s37, s17, 0
  s_sub_u32 s38, 114688, s45
  s_mov_b32 s39, 0x20000
  v_lshrrev_b32 v2, 3, v1
  v_and_b32 v3, 7, v1
  v_mul_u32_u24 v8, 144, v2
  v_lshl_add_u32 v8, v3, 4, v8
  v_mul_u32_u24 v2, 896, v2
  v_lshl_add_u32 v2, v3, 4, v2
  s_mov_b32 s44, 0
  buffer_load_dwordx4 v[160:163], v2, s[36:39], s44 offen nt
  s_add_u32 s44, s44, 7168
  buffer_load_dwordx4 v[164:167], v2, s[36:39], s44 offen nt
  s_add_u32 s44, s44, 7168
  buffer_load_dwordx4 v[168:171], v2, s[36:39], s44 offen nt
  s_add_u32 s44, s44, 7168
  buffer_load_dwordx4 v[172:175], v2, s[36:39], s44 offen nt
  s_add_u32 s44, s44, 7168
  buffer_load_dwordx4 v[176:179], v2, s[36:39], s44 offen nt
  s_add_u32 s44, s44, 7168
  buffer_load_dwordx4 v[180:183], v2, s[36:39], s44 offen nt
  s_add_u32 s44, s44, 7168
  buffer_load_dwordx4 v[184:187], v2, s[36:39], s44 offen nt
  s_add_u32 s44, s44, 7168
  buffer_load_dwordx4 v[188:191], v2, s[36:39], s44 offen nt
  s_add_u32 s44, s44, 7168
  buffer_load_dwordx4 v[192:195], v2, s[36:39], s44 offen nt
  s_add_u32 s44, s44, 7168
  buffer_load_dwordx4 v[196:199], v2, s[36:39], s44 offen nt
  s_add_u32 s44, s44, 7168
  buffer_load_dwordx4 v[200:203], v2, s[36:39], s44 offen nt
  s_add_u32 s44, s44, 7168
  buffer_load_dwordx4 v[204:207], v2, s[36:39], s44 offen nt
  s_add_u32 s44, s44, 7168
  buffer_load_dwordx4 v[208:211], v2, s[36:39], s44 offen nt
  s_add_u32 s44, s44, 7168
  buffer_load_dwordx4 v[212:215], v2, s[36:39], s44 offen nt
  s_add_u32 s44, s44, 7168
  buffer_load_dwordx4 v[216:219], v2, s[36:39], s44 offen nt
  s_add_u32 s44, s44, 7168
  buffer_load_dwordx4 v[220:223], v2, s[36:39], s44 offen nt
  s_add_u32 s44, s44, 7168
  v_lshlrev_b32 v3, 4, v1
  v_mov_b32 v224, 0
  v_mov_b32 v225, 0
  v_mov_b32 v226, 0
  v_mov_b32 v227, 0
  ds_write_b128 v3, v[224:227] offset:52480
  ds_write_b128 v3, v[224:227] offset:53504
  ds_write_b128 v3, v[224:227] offset:54528
  s_waitcnt vmcnt(15)
  ds_write_b128 v8, v[160:163] offset:34048
  s_waitcnt vmcnt(14)
  ds_write_b128 v8, v[164:167] offset:35200
  s_waitcnt vmcnt(13)
  ds_write_b128 v8, v[168:171] offset:36352
  s_waitcnt vmcnt(12)
  ds_write_b128 v8, v[172:175] offset:37504
  s_waitcnt vmcnt(11)
  ds_write_b128 v8, v[176:179] offset:38656
  s_waitcnt vmcnt(10)
  ds_write_b128 v8, v[180:183] offset:39808
  s_waitcnt vmcnt(9)
  ds_write_b128 v8, v[184:187] offset:40960
  s_waitcnt vmcnt(8)
  ds_write_b128 v8, v[188:191] offset:42112
  s_waitcnt vmcnt(7)
  ds_write_b128 v8, v[192:195] offset:43264
  s_waitcnt vmcnt(6)
  ds_write_b128 v8, v[196:199] offset:44416
  s_waitcnt vmcnt(5)
  ds_write_b128 v8, v[200:203] offset:45568
  s_waitcnt vmcnt(4)
  ds_write_b128 v8, v[204:207] offset:46720
  s_waitcnt vmcnt(3)
  ds_write_b128 v8, v[208:211] offset:47872
  s_waitcnt vmcnt(2)
  ds_write_b128 v8, v[212:215] offset:49024
  s_waitcnt vmcnt(1)
  ds_write_b128 v8, v[216:219] offset:50176
  s_waitcnt vmcnt(0)
  ds_write_b128 v8, v[220:223] offset:51328
L_wfl:
  v_mov_b32 v6, 0
  v_mov_b32 v7, s6
  s_waitcnt lgkmcnt(0)
  ds_write_b32 v6, v7 offset:20
L_wst:
  v_mov_b32 v6, 0
  s_mov_b32 s19, 262144
L_wsw:
  s_sleep 8
  ds_read_b32 v7, v6 offset:20
  s_sub_u32 s19, s19, 1
  s_cbranch_scc1 L_exit
  s_waitcnt lgkmcnt(0)
  v_cmp_ne_u32 vcc, s6, v7
  s_cbranch_vccnz L_wsw
  s_mul_i32 s44, s34, 3
  s_add_u32 s43, s43, s44
  s_mul_i32 s44, s43, 14
  s_lshl_b32 s45, s42, 6
  s_sub_u32 s44, s44, s45
  v_mul_u32_u24 v2, 864, v5
  v_cmp_gt_u32 s[46:47], 14, v14
  v_add_u32 v3, s44, v14
  v_cmp_gt_u32 vcc, 64, v3
  v_lshl_add_u32 v3, v3, 1, v2
  s_and_b64 s[48:49], vcc, s[46:47]
  s_mov_b64 exec, s[48:49]
  s_cbranch_execz L_wb3
  ds_read_u16 v16, v3 offset:34048
  ds_read_u16 v17, v3 offset:34192
  ds_read_u16 v18, v3 offset:34336
  ds_read_u16 v19, v3 offset:34480
  ds_read_u16 v20, v3 offset:34624
  ds_read_u16 v21, v3 offset:34768
  ds_read_u16 v22, v3 offset:37504
  ds_read_u16 v23, v3 offset:37648
  ds_read_u16 v24, v3 offset:37792
  ds_read_u16 v25, v3 offset:37936
  ds_read_u16 v26, v3 offset:38080
  ds_read_u16 v27, v3 offset:38224
  s_waitcnt lgkmcnt(0)
  v_lshl_or_b32 v64, v17, 16, v16
  v_lshl_or_b32 v65, v19, 16, v18
  v_lshl_or_b32 v66, v21, 16, v20
  v_lshl_or_b32 v76, v23, 16, v22
  v_lshl_or_b32 v77, v25, 16, v24
  v_lshl_or_b32 v78, v27, 16, v26
  ds_read_u16 v16, v3 offset:40960
  ds_read_u16 v17, v3 offset:41104
  ds_read_u16 v18, v3 offset:41248
  ds_read_u16 v19, v3 offset:41392
  ds_read_u16 v20, v3 offset:41536
  ds_read_u16 v21, v3 offset:41680
  ds_read_u16 v22, v3 offset:44416
  ds_read_u16 v23, v3 offset:44560
  ds_read_u16 v24, v3 offset:44704
  ds_read_u16 v25, v3 offset:44848
  ds_read_u16 v26, v3 offset:44992
  ds_read_u16 v27, v3 offset:45136
  s_waitcnt lgkmcnt(0)
  v_lshl_or_b32 v88, v17, 16, v16
  v_lshl_or_b32 v89, v19, 16, v18
  v_lshl_or_b32 v90, v21, 16, v20
  v_lshl_or_b32 v100, v23, 16, v22
  v_lshl_or_b32 v101, v25, 16, v24
  v_lshl_or_b32 v102, v27, 16, v26
  ds_read_u16 v16, v3 offset:47872
  ds_read_u16 v17, v3 offset:48016
  ds_read_u16 v18, v3 offset:48160
  ds_read_u16 v19, v3 offset:48304
  ds_read_u16 v20, v3 offset:48448
  ds_read_u16 v21, v3 offset:48592
  ds_read_u16 v22, v3 offset:51328
  ds_read_u16 v23, v3 offset:51472
  ds_read_u16 v24, v3 offset:51616
  ds_read_u16 v25, v3 offset:51760
  ds_read_u16 v26, v3 offset:51904
  ds_read_u16 v27, v3 offset:52048
  s_waitcnt lgkmcnt(0)
  v_lshl_or_b32 v112, v17, 16, v16
  v_lshl_or_b32 v113, v19, 16, v18
  v_lshl_or_b32 v114, v21, 16, v20
  v_lshl_or_b32 v124, v23, 16, v22
  v_lshl_or_b32 v125, v25, 16, v24
  v_lshl_or_b32 v126, v27, 16, v26
L_wb3:
  s_mov_b64 exec, -1
  s_add_u32 s44, s44, 14
  v_add_u32 v3, s44, v14
  v_cmp_gt_u32 vcc, 64, v3
  v_lshl_add_u32 v3, v3, 1, v2
  s_and_b64 s[50:51], vcc, s[46:47]
  s_mov_b64 exec, s[50:51]
  s_cbranch_execz L_wb4
  ds_read_u16 v16, v3 offset:34048
  ds_read_u16 v17, v3 offset:34192
  ds_read_u16 v18, v3 offset:34336
  ds_read_u16 v19, v3 offset:34480
  ds_read_u16 v20, v3 offset:34624
  ds_read_u16 v21, v3 offset:34768
  ds_read_u16 v22, v3 offset:37504
  ds_read_u16 v23, v3 offset:37648
  ds_read_u16 v24, v3 offset:37792
  ds_read_u16 v25, v3 offset:37936
  ds_read_u16 v26, v3 offset:38080
  ds_read_u16 v27, v3 offset:38224
  s_waitcnt lgkmcnt(0)
  v_lshl_or_b32 v68, v17, 16, v16
  v_lshl_or_b32 v69, v19, 16, v18
  v_lshl_or_b32 v70, v21, 16, v20
  v_lshl_or_b32 v80, v23, 16, v22
  v_lshl_or_b32 v81, v25, 16, v24
  v_lshl_or_b32 v82, v27, 16, v26
  ds_read_u16 v16, v3 offset:40960
  ds_read_u16 v17, v3 offset:41104
  ds_read_u16 v18, v3 offset:41248
  ds_read_u16 v19, v3 offset:41392
  ds_read_u16 v20, v3 offset:41536
  ds_read_u16 v21, v3 offset:41680
  ds_read_u16 v22, v3 offset:44416
  ds_read_u16 v23, v3 offset:44560
  ds_read_u16 v24, v3 offset:44704
  ds_read_u16 v25, v3 offset:44848
  ds_read_u16 v26, v3 offset:44992
  ds_read_u16 v27, v3 offset:45136
  s_waitcnt lgkmcnt(0)
  v_lshl_or_b32 v92, v17, 16, v16
  v_lshl_or_b32 v93, v19, 16, v18
  v_lshl_or_b32 v94, v21, 16, v20
  v_lshl_or_b32 v104, v23, 16, v22
  v_lshl_or_b32 v105, v25, 16, v24
  v_lshl_or_b32 v106, v27, 16, v26
  ds_read_u16 v16, v3 offset:47872
  ds_read_u16 v17, v3 offset:48016
  ds_read_u16 v18, v3 offset:48160
  ds_read_u16 v19, v3 offset:48304
  ds_read_u16 v20, v3 offset:48448
  ds_read_u16 v21, v3 offset:48592
  ds_read_u16 v22, v3 offset:51328
  ds_read_u16 v23, v3 offset:51472
  ds_read_u16 v24, v3 offset:51616
  ds_read_u16 v25, v3 offset:51760
  ds_read_u16 v26, v3 offset:51904
  ds_read_u16 v27, v3 offset:52048
  s_waitcnt lgkmcnt(0)
  v_lshl_or_b32 v116, v17, 16, v16
  v_lshl_or_b32 v117, v19, 16, v18
  v_lshl_or_b32 v118, v21, 16, v20
  v_lshl_or_b32 v128, v23, 16, v22
  v_lshl_or_b32 v129, v25, 16, v24
  v_lshl_or_b32 v130, v27, 16, v26
L_wb4:
  s_mov_b64 exec, -1
  s_add_u32 s44, s44, 14
  v_add_u32 v3, s44, v14
  v_cmp_gt_u32 vcc, 64, v3
  v_lshl_add_u32 v3, v3, 1, v2
  s_and_b64 s[52:53], vcc, s[46:47]
  s_mov_b64 exec, s[52:53]
  s_cbranch_execz L_wb5
  ds_read_u16 v16, v3 offset:34048
  ds_read_u16 v17, v3 offset:34192
  ds_read_u16 v18, v3 offset:34336
  ds_read_u16 v19, v3 offset:34480
  ds_read_u16 v20, v3 offset:34624
  ds_read_u16 v21, v3 offset:34768
  ds_read_u16 v22, v3 offset:37504
  ds_read_u16 v23, v3 offset:37648
  ds_read_u16 v24, v3 offset:37792
  ds_read_u16 v25, v3 offset:37936
  ds_read_u16 v26, v3 offset:38080
  ds_read_u16 v27, v3 offset:38224
  s_waitcnt lgkmcnt(0)
  v_lshl_or_b32 v72, v17, 16, v16
  v_lshl_or_b32 v73, v19, 16, v18
  v_lshl_or_b32 v74, v21, 16, v20
  v_lshl_or_b32 v84, v23, 16, v22
  v_lshl_or_b32 v85, v25, 16, v24
  v_lshl_or_b32 v86, v27, 16, v26
  ds_read_u16 v16, v3 offset:40960
  ds_read_u16 v17, v3 offset:41104
  ds_read_u16 v18, v3 offset:41248
  ds_read_u16 v19, v3 offset:41392
  ds_read_u16 v20, v3 offset:41536
  ds_read_u16 v21, v3 offset:41680
  ds_read_u16 v22, v3 offset:44416
  ds_read_u16 v23, v3 offset:44560
  ds_read_u16 v24, v3 offset:44704
  ds_read_u16 v25, v3 offset:44848
  ds_read_u16 v26, v3 offset:44992
  ds_read_u16 v27, v3 offset:45136
  s_waitcnt lgkmcnt(0)
  v_lshl_or_b32 v96, v17, 16, v16
  v_lshl_or_b32 v97, v19, 16, v18
  v_lshl_or_b32 v98, v21, 16, v20
  v_lshl_or_b32 v108, v23, 16, v22
  v_lshl_or_b32 v109, v25, 16, v24
  v_lshl_or_b32 v110, v27, 16, v26
  ds_read_u16 v16, v3 offset:47872
  ds_read_u16 v17, v3 offset:48016
  ds_read_u16 v18, v3 offset:48160
  ds_read_u16 v19, v3 offset:48304
  ds_read_u16 v20, v3 offset:48448
  ds_read_u16 v21, v3 offset:48592
  ds_read_u16 v22, v3 offset:51328
  ds_read_u16 v23, v3 offset:51472
  ds_read_u16 v24, v3 offset:51616
  ds_read_u16 v25, v3 offset:51760
  ds_read_u16 v26, v3 offset:51904
  ds_read_u16 v27, v3 offset:52048
  s_waitcnt lgkmcnt(0)
  v_lshl_or_b32 v120, v17, 16, v16
  v_lshl_or_b32 v121, v19, 16, v18
  v_lshl_or_b32 v122, v21, 16, v20
  v_lshl_or_b32 v132, v23, 16, v22
  v_lshl_or_b32 v133, v25, 16, v24
  v_lshl_or_b32 v134, v27, 16, v26
L_wb5:
  s_mov_b64 exec, -1
  s_add_u32 s44, s44, 14
  s_lshr_b32 s44, s40, 4
  s_lshl_b32 s44, s44, 13
  s_lshl_b32 s45, s40, 14
  s_add_u32 s44, s44, s45
  s_add_u32 s44, s44, 1048576
  v_mul_u32_u24 v2, 384, v14
  v_lshl_add_u32 v2, v5, 4, v2
  v_add_u32 v2, s44, v2
  s_and_b32 s44, s40, 1
  s_lshl_b32 s44, s44, 14
  s_lshl_b32 s46, s43, 6
  s_add_u32 s44, s44, s46
  s_add_u32 s44, s44, 1572864
  v_xor_b32 v3, 1, v5
  v_and_b32 v3, 1, v3
  v_lshlrev_b32 v3, 13, v3
  v_lshl_add_u32 v3, v5, 11, v3
  v_lshl_add_u32 v3, v14, 2, v3
  v_add_u32 v3, s44, v3
  v_cmp_eq_u32 vcc, 15, v14
  v_lshlrev_b32 v8, 4, v5
  v_add_u32 v8, 64, v8
  v_cndmask_b32 v4, 0, 1.0, vcc
  v_cmp_eq_u32 s[46:47], 1, v5
  s_sub_u32 s18, s2, 4
  s_mul_i32 s56, s18, 964
  s_lshr_b32 s56, s56, 16
  s_mul_i32 s19, s56, 68
  s_cmp_eq_u32 s18, s19
  s_cselect_b32 s56, s56, 4
  s_cmp_eq_u32 s34, 1
  s_cselect_b32 s56, s56, 4
  s_cmp_ge_u32 s56, 4
  s_cbranch_scc1 L_wai
  s_add_u32 s58, s32, 360512
  s_addc_u32 s59, s33, 0
  s_mov_b32 s19, 262144
L_ccw:
  s_load_dwordx8 s[60:67], s[58:59], 0 glc
  s_sub_u32 s19, s19, 1
  s_cbranch_scc1 L_exit
  s_waitcnt lgkmcnt(0)
  s_xor_b32 s7, s60, s6
  s_xor_b32 s18, s62, s6
  s_or_b32 s7, s7, s18
  s_xor_b32 s18, s64, s6
  s_or_b32 s7, s7, s18
  s_xor_b32 s18, s66, s6
  s_or_b32 s7, s7, s18
  s_cbranch_scc0 L_ccw2
  s_sleep 16
  s_branch L_ccw
L_ccw2:
  s_add_i32 s58, s61, s63
  s_add_i32 s60, s65, s67
  s_add_i32 s58, s58, s60
  v_mov_b32 v10, s6
  s_cmp_gt_i32 s58, 0
  s_cselect_b32 s57, 0x2000, 0
  v_mov_b32 v11, s57
  s_and_b32 s18, s56, 1
  s_xor_b32 s18, s18, 1
  s_lshl_b32 s18, s18, 13
  s_xor_b32 s57, s57, s18
  s_lshl_b32 s18, s56, 11
  s_add_u32 s18, s18, s57
  s_add_u32 s18, s18, 1572864
  v_lshl_add_u32 v224, v1, 4, s18
  v_add_u32 v225, 16384, v224
  v_mov_b32 v16, 0
  v_mov_b32 v17, 0
  v_mov_b32 v18, 0
  v_mov_b32 v19, 0
  global_store_dwordx4 v224, v[16:19], s[32:33] sc1
  global_store_dwordx4 v224, v[16:19], s[32:33] offset:1024 sc1
  global_store_dwordx4 v225, v[16:19], s[32:33] sc1
  global_store_dwordx4 v225, v[16:19], s[32:33] offset:1024 sc1
  s_lshl_b32 s18, s56, 3
  s_add_u32 s18, s18, 360448
  v_mov_b32 v9, s18
  s_waitcnt vmcnt(0)
  s_mov_b64 exec, 1
  global_store_dwordx2 v9, v[10:11], s[32:33] sc1
  s_mov_b64 exec, -1
L_wai:
  v_mov_b32 v6, 0
  s_mov_b32 s19, 262144
L_wre:
  s_sleep 16
  ds_read_b32 v7, v6 offset:592
  s_sub_u32 s19, s19, 1
  s_cbranch_scc1 L_exit
  s_waitcnt lgkmcnt(0)
  v_cmp_ne_u32 vcc, s6, v7
  s_cbranch_vccnz L_wre
  s_add_u32 s56, s32, 360448
  s_addc_u32 s57, s33, 0
  s_mov_b32 s19, 262144
  s_load_dwordx8 s[60:67], s[56:57], 0
L_wr:
  s_waitcnt lgkmcnt(0)
  s_xor_b32 s7, s60, s6
  s_xor_b32 s18, s62, s6
  s_or_b32 s7, s7, s18
  s_xor_b32 s18, s64, s6
  s_or_b32 s7, s7, s18
  s_xor_b32 s18, s66, s6
  s_or_b32 s7, s7, s18
  s_cbranch_scc0 L_wr2
  v_mov_b32 v9, 360448
  v_lshl_add_u32 v9, v5, 3, v9
L_wr1:
  s_sleep 40
  global_load_dwordx2 v[10:11], v9, s[32:33] sc1
  s_sub_u32 s19, s19, 1
  s_cbranch_scc1 L_exit
  s_waitcnt vmcnt(0)
  v_cmp_ne_u32 vcc, s6, v10
  s_cbranch_vccnz L_wr1
  v_readfirstlane_b32 s61, v11
  s_nop 1
L_wr2:
  v_mov_b32 v9, 0
  v_mov_b32 v10, s6
  v_mov_b32 v11, s61
  ds_write_b64 v9, v[10:11] offset:24
  v_xor_b32 v2, v11, v2
  v_xor_b32 v3, v11, v3
  v_mov_b32 v6, 0
  s_mov_b32 s19, 262144
L_wd:
  s_sleep 1
  ds_read_b32 v7, v6 offset:16
  s_sub_u32 s19, s19, 1
  s_cbranch_scc1 L_exit
  s_waitcnt lgkmcnt(0)
  v_cmp_gt_u32 vcc, 5, v7
  s_cbranch_vccnz L_wd
  s_setprio 3
  s_mov_b32 s19, 262144
L_wp:
  global_load_dwordx4 v[160:163], v2, s[32:33] offset:0 sc1
  global_load_dwordx4 v[164:167], v2, s[32:33] offset:64 sc1
  global_load_dwordx4 v[168:171], v2, s[32:33] offset:128 sc1
  global_load_dwordx4 v[172:175], v2, s[32:33] offset:192 sc1
  global_load_dwordx4 v[176:179], v2, s[32:33] offset:256 sc1
  global_load_dwordx4 v[180:183], v2, s[32:33] offset:320 sc1
  s_sub_u32 s19, s19, 1
  s_cbranch_scc1 L_exit
  s_waitcnt vmcnt(5)
  v_xor_b32 v9, s6, v163
  s_waitcnt vmcnt(4)
  v_bitop3_b32 v9, v167, s6, v9 bitop3:0xbe
  s_waitcnt vmcnt(3)
  v_bitop3_b32 v9, v171, s6, v9 bitop3:0xbe
  s_waitcnt vmcnt(2)
  v_bitop3_b32 v9, v175, s6, v9 bitop3:0xbe
  s_waitcnt vmcnt(1)
  v_bitop3_b32 v9, v179, s6, v9 bitop3:0xbe
  s_waitcnt vmcnt(0)
  v_bitop3_b32 v9, v183, s6, v9 bitop3:0xbe
  v_cmp_ne_u32 vcc, 0, v9
  s_and_b64 exec, exec, vcc
  s_cbranch_execnz L_wp
  s_mov_b64 exec, -1
  v_mov_b32 v10, v181
  v_cndmask_b32 v181, v181, 0, s[46:47]
  v_mfma_f32_16x16x32_bf16 v[204:207], v[160:163], v[64:67], 0
  v_mfma_f32_16x16x32_bf16 v[208:211], v[160:163], v[68:71], 0
  v_mfma_f32_16x16x32_bf16 v[212:215], v[160:163], v[72:75], 0
  v_max_f32_dpp v11, v10, v10 quad_perm:[1,0,3,2] row_mask:0xf bank_mask:0xf
  v_mfma_f32_16x16x32_bf16 v[204:207], v[164:167], v[76:79], v[204:207]
  v_mfma_f32_16x16x32_bf16 v[208:211], v[164:167], v[80:83], v[208:211]
  v_mfma_f32_16x16x32_bf16 v[212:215], v[164:167], v[84:87], v[212:215]
  v_max_f32_dpp v11, v11, v11 quad_perm:[2,3,0,1] row_mask:0xf bank_mask:0xf
  v_sub_f32 v10, v10, v11
  v_exp_f32 v10, v10
  v_mfma_f32_16x16x32_bf16 v[204:207], v[168:171], v[88:91], v[204:207]
  v_mfma_f32_16x16x32_bf16 v[208:211], v[168:171], v[92:95], v[208:211]
  v_mfma_f32_16x16x32_bf16 v[212:215], v[168:171], v[96:99], v[212:215]
  v_add_f32_dpp v11, v10, v10 quad_perm:[1,0,3,2] row_mask:0xf bank_mask:0xf
  v_mfma_f32_16x16x32_bf16 v[204:207], v[172:175], v[100:103], v[204:207]
  v_mfma_f32_16x16x32_bf16 v[208:211], v[172:175], v[104:107], v[208:211]
  v_mfma_f32_16x16x32_bf16 v[212:215], v[172:175], v[108:111], v[212:215]
  v_add_f32_dpp v11, v11, v11 quad_perm:[2,3,0,1] row_mask:0xf bank_mask:0xf
  v_rcp_f32 v11, v11
  s_nop 0
  v_mul_f32 v10, v10, v11
  ds_bpermute_b32 v16, v8, v10 offset:0
  ds_bpermute_b32 v17, v8, v10 offset:4
  ds_bpermute_b32 v18, v8, v10 offset:8
  ds_bpermute_b32 v19, v8, v10 offset:12
  v_mfma_f32_16x16x32_bf16 v[204:207], v[176:179], v[112:115], v[204:207]
  v_mfma_f32_16x16x32_bf16 v[208:211], v[176:179], v[116:119], v[208:211]
  v_mfma_f32_16x16x32_bf16 v[212:215], v[176:179], v[120:123], v[212:215]
  v_mfma_f32_16x16x32_bf16 v[204:207], v[180:183], v[124:127], v[204:207]
  v_mfma_f32_16x16x32_bf16 v[208:211], v[180:183], v[128:131], v[208:211]
  v_mfma_f32_16x16x32_bf16 v[212:215], v[180:183], v[132:135], v[212:215]
  s_cmp_eq_u64 s[52:53], 0
  s_waitcnt lgkmcnt(0)
  s_nop 3
  v_fma_f32 v20, v16, v204, v4
  v_fmac_f32 v20, v17, v205
  v_fmac_f32 v20, v18, v206
  v_fmac_f32 v20, v19, v207
  global_atomic_add_f32 v3, v20, s[32:33] offset:0
  v_fma_f32 v21, v16, v208, v4
  v_fmac_f32 v21, v17, v209
  v_fmac_f32 v21, v18, v210
  v_fmac_f32 v21, v19, v211
  global_atomic_add_f32 v3, v21, s[32:33] offset:64
  v_fma_f32 v22, v16, v212, v4
  v_fmac_f32 v22, v17, v213
  v_fmac_f32 v22, v18, v214
  v_fmac_f32 v22, v19, v215
  s_cbranch_scc1 L_wend
  global_atomic_add_f32 v3, v22, s[32:33] offset:128
L_wend:
  s_endpgm
L_widle:
  s_cmp_lg_u32 s34, 1
  s_cbranch_scc1 L_exit
  s_cmp_ge_u32 s2, 16
  s_cbranch_scc1 L_wi2
  s_bitcmp1_b32 s2, 2
  s_cbranch_scc1 L_wi2
  s_setprio 3
  s_and_b32 s52, s2, 3
  s_mul_i32 s40, s52, 1920
  s_add_u32 s40, s40, 1703936
  s_add_u32 s40, s32, s40
  s_addc_u32 s41, s33, 0
  s_load_dword s48, s[40:41], 0 glc
  s_load_dword s49, s[40:41], 8192 glc
  s_load_dword s48, s[40:41], 640 glc
  s_load_dword s49, s[40:41], 8832 glc
  s_load_dword s48, s[40:41], 1280 glc
  s_load_dword s49, s[40:41], 9472 glc
  s_mov_b32 s42, 0
  s_mov_b32 s43, 3
  s_memrealtime s[56:57]
  s_waitcnt lgkmcnt(0)
L_wpr:
  s_mov_b32 s50, -1
  s_mov_b32 s51, -1
  s_memtime s[44:45]
  s_waitcnt lgkmcnt(0)
  s_load_dword s48, s[40:41], 0 glc
  s_waitcnt lgkmcnt(0)
  s_memtime s[46:47]
  s_waitcnt lgkmcnt(0)
  s_sub_u32 s49, s46, s44
  s_min_u32 s50, s50, s49
  s_memtime s[44:45]
  s_waitcnt lgkmcnt(0)
  s_load_dword s48, s[40:41], 8192 glc
  s_waitcnt lgkmcnt(0)
  s_memtime s[46:47]
  s_waitcnt lgkmcnt(0)
  s_sub_u32 s49, s46, s44
  s_min_u32 s51, s51, s49
  s_memtime s[44:45]
  s_waitcnt lgkmcnt(0)
  s_load_dword s48, s[40:41], 0 glc
  s_waitcnt lgkmcnt(0)
  s_memtime s[46:47]
  s_waitcnt lgkmcnt(0)
  s_sub_u32 s49, s46, s44
  s_min_u32 s50, s50, s49
  s_memtime s[44:45]
  s_waitcnt lgkmcnt(0)
  s_load_dword s48, s[40:41], 8192 glc
  s_waitcnt lgkmcnt(0)
  s_memtime s[46:47]
  s_waitcnt lgkmcnt(0)
  s_sub_u32 s49, s46, s44
  s_min_u32 s51, s51, s49
  s_cmp_lt_u32 s51, s50
  s_cselect_b32 s49, 1, -1
  s_add_i32 s42, s42, s49
  s_add_u32 s40, s40, 640
  s_addc_u32 s41, s41, 0
  s_memrealtime s[58:59]
  s_sub_u32 s43, s43, 1
  s_waitcnt lgkmcnt(0)
  s_sub_u32 s49, s58, s56
  s_cmp_gt_u32 s49, 900
  s_cselect_b32 s43, 0, s43
  s_cmp_lg_u32 s43, 0
  s_cbranch_scc1 L_wpr
  s_lshl_b32 s52, s52, 3
  s_add_u32 s52, s52, 360512
  v_mov_b32 v9, s52
  v_mov_b32 v10, s6
  v_mov_b32 v11, s42
  s_mov_b64 exec, 1
  global_store_dwordx2 v9, v[10:11], s[32:33] sc1
  s_mov_b64 exec, -1
  s_setprio 0
L_wi2:
  v_lshrrev_b32 v5, 4, v1
  v_mov_b32 v6, 0
  s_mov_b32 s19, 262144
L_wire:
  s_sleep 16
  ds_read_b32 v7, v6 offset:592
  s_sub_u32 s19, s19, 1
  s_cbranch_scc1 L_exit
  s_waitcnt lgkmcnt(0)
  v_cmp_ne_u32 vcc, s6, v7
  s_cbranch_vccnz L_wire
  s_add_u32 s56, s32, 360448
  s_addc_u32 s57, s33, 0
  s_mov_b32 s19, 262144
  s_load_dwordx8 s[60:67], s[56:57], 0
L_wir:
  s_waitcnt lgkmcnt(0)
  s_xor_b32 s7, s60, s6
  s_xor_b32 s18, s62, s6
  s_or_b32 s7, s7, s18
  s_xor_b32 s18, s64, s6
  s_or_b32 s7, s7, s18
  s_xor_b32 s18, s66, s6
  s_or_b32 s7, s7, s18
  s_cbranch_scc0 L_wir2
  v_mov_b32 v9, 360448
  v_lshl_add_u32 v9, v5, 3, v9
L_wir1:
  s_sleep 40
  global_load_dwordx2 v[10:11], v9, s[32:33] sc1
  s_sub_u32 s19, s19, 1
  s_cbranch_scc1 L_exit
  s_waitcnt vmcnt(0)
  v_cmp_ne_u32 vcc, s6, v10
  s_cbranch_vccnz L_wir1
  v_readfirstlane_b32 s61, v11
  s_nop 1
L_wir2:
  v_mov_b32 v9, 0
  v_mov_b32 v10, s6
  v_mov_b32 v11, s61
  ds_write_b64 v9, v[10:11] offset:24
  s_endpgm
L_cons:
  s_mov_b32 s36, s8
  s_mov_b32 s37, s9
  s_mov_b32 s38, 3584
  s_mov_b32 s39, 0x20000
  s_mov_b32 s40, s28
  s_mov_b32 s41, s29
  s_mov_b32 s42, 3584
  s_mov_b32 s43, 0x20000
  s_mul_i32 s44, s35, 896
  v_lshrrev_b32 v6, 2, v1
  v_and_b32 v3, 3, v1
  v_mul_u32_u24 v2, 28, v6
  v_lshl_add_u32 v2, v3, 3, v2
  buffer_load_dword v8, v2, s[36:39], s44 offen offset:0
  buffer_load_dword v9, v2, s[36:39], s44 offen offset:4
  buffer_load_dword v10, v2, s[36:39], s44 offen offset:448
  buffer_load_dword v11, v2, s[36:39], s44 offen offset:452
  s_mov_b32 s46, 0x88888888
  s_mov_b32 s47, 0x88888888
  s_mov_b32 s62, 0x3b124925
  s_mov_b32 s63, 0x3727c5ac
  s_mov_b32 s48, 8720
  v_lshrrev_b32 v60, v6, s48
  v_and_b32 v60, 1, v60
  v_add_u32 v60, 1, v60
  v_mul_u32_u24 v60, 16, v60
  v_cvt_f32_u32 v60, v60
  s_mov_b32 s48, 2116
  v_lshrrev_b32 v61, v6, s48
  v_and_b32 v61, 1, v61
  v_add_u32 v61, 1, v61
  v_mul_u32_u24 v61, 16, v61
  v_cvt_f32_u32 v61, v61
  s_waitcnt vmcnt(0)
  v_lshlrev_b32 v12, 16, v8
  v_and_b32 v13, 0xffff0000, v8
  v_lshlrev_b32 v14, 16, v9
  v_and_b32 v15, 0xffff0000, v9
  v_lshlrev_b32 v16, 16, v10
  v_and_b32 v17, 0xffff0000, v10
  v_lshlrev_b32 v18, 16, v11
  v_and_b32 v19, 0xffff0000, v11
  v_lshlrev_b32 v7, 4, v1
  v_add_u32 v62, 327680, v7
  v_mul_u32_u24 v3, 12, v1
  v_add_u32 v3, 27648, v3
  v_mov_b32 v6, 0
  s_mov_b32 s19, 262144
L_cte:
  s_sleep 16
  ds_read_b32 v7, v6 offset:592
  s_sub_u32 s19, s19, 1
  s_cbranch_scc1 L_exit
  s_waitcnt lgkmcnt(0)
  v_cmp_ne_u32 vcc, s6, v7
  s_cbranch_vccnz L_cte
  s_mov_b32 s19, 262144
  global_load_dwordx4 v[160:163], v62, s[32:33] offset:0
  global_load_dwordx4 v[164:167], v62, s[32:33] offset:1024
  global_load_dwordx4 v[168:171], v62, s[32:33] offset:2048
  global_load_dwordx4 v[172:175], v62, s[32:33] offset:3072
  v_add_u32 v62, 4096, v62
  global_load_dwordx4 v[176:179], v62, s[32:33] offset:0
  global_load_dwordx4 v[180:183], v62, s[32:33] offset:1024
  global_load_dwordx4 v[184:187], v62, s[32:33] offset:2048
  global_load_dwordx4 v[188:191], v62, s[32:33] offset:3072
  v_add_u32 v62, 4096, v62
  global_load_dwordx4 v[192:195], v62, s[32:33] offset:0
  global_load_dwordx4 v[196:199], v62, s[32:33] offset:1024
  global_load_dwordx4 v[200:203], v62, s[32:33] offset:2048
  global_load_dwordx4 v[204:207], v62, s[32:33] offset:3072
  v_add_u32 v62, 4096, v62
  global_load_dwordx4 v[208:211], v62, s[32:33] offset:0
  global_load_dwordx4 v[212:215], v62, s[32:33] offset:1024
  global_load_dwordx4 v[216:219], v62, s[32:33] offset:2048
  global_load_dwordx4 v[220:223], v62, s[32:33] offset:3072
  s_branch L_ct1
L_ct:
  global_load_dwordx4 v[160:163], v62, s[32:33] offset:0 sc1
  global_load_dwordx4 v[164:167], v62, s[32:33] offset:1024 sc1
  global_load_dwordx4 v[168:171], v62, s[32:33] offset:2048 sc1
  global_load_dwordx4 v[172:175], v62, s[32:33] offset:3072 sc1
  v_add_u32 v62, 4096, v62
  global_load_dwordx4 v[176:179], v62, s[32:33] offset:0 sc1
  global_load_dwordx4 v[180:183], v62, s[32:33] offset:1024 sc1
  global_load_dwordx4 v[184:187], v62, s[32:33] offset:2048 sc1
  global_load_dwordx4 v[188:191], v62, s[32:33] offset:3072 sc1
  v_add_u32 v62, 4096, v62
  global_load_dwordx4 v[192:195], v62, s[32:33] offset:0 sc1
  global_load_dwordx4 v[196:199], v62, s[32:33] offset:1024 sc1
  global_load_dwordx4 v[200:203], v62, s[32:33] offset:2048 sc1
  global_load_dwordx4 v[204:207], v62, s[32:33] offset:3072 sc1
  v_add_u32 v62, 4096, v62
  global_load_dwordx4 v[208:211], v62, s[32:33] offset:0 sc1
  global_load_dwordx4 v[212:215], v62, s[32:33] offset:1024 sc1
  global_load_dwordx4 v[216:219], v62, s[32:33] offset:2048 sc1
  global_load_dwordx4 v[220:223], v62, s[32:33] offset:3072 sc1
L_ct1:
  v_subrev_u32 v62, 12288, v62
  s_sub_u32 s19, s19, 1
  s_cbranch_scc1 L_exit
  s_waitcnt vmcnt(0)
  v_xor_b32 v9, s6, v163
  v_bitop3_b32 v9, v167, s6, v9 bitop3:0xbe
  v_bitop3_b32 v9, v171, s6, v9 bitop3:0xbe
  v_bitop3_b32 v9, v175, s6, v9 bitop3:0xbe
  v_bitop3_b32 v9, v179, s6, v9 bitop3:0xbe
  v_bitop3_b32 v9, v183, s6, v9 bitop3:0xbe
  v_bitop3_b32 v9, v187, s6, v9 bitop3:0xbe
  v_bitop3_b32 v9, v191, s6, v9 bitop3:0xbe
  v_bitop3_b32 v9, v195, s6, v9 bitop3:0xbe
  v_bitop3_b32 v9, v199, s6, v9 bitop3:0xbe
  v_bitop3_b32 v9, v203, s6, v9 bitop3:0xbe
  v_bitop3_b32 v9, v207, s6, v9 bitop3:0xbe
  v_bitop3_b32 v9, v211, s6, v9 bitop3:0xbe
  v_bitop3_b32 v9, v215, s6, v9 bitop3:0xbe
  v_bitop3_b32 v9, v219, s6, v9 bitop3:0xbe
  v_bitop3_b32 v9, v223, s6, v9 bitop3:0xbe
  v_cmp_ne_u32 vcc, 0, v9
  s_cbranch_vccz L_ct2
  s_sleep 64
  s_branch L_ct
L_ct2:
  ds_write2_b32 v3, v160, v161 offset0:0 offset1:1
  ds_write_b32 v3, v162 offset:8
  v_add_u32 v3, 768, v3
  ds_write2_b32 v3, v164, v165 offset0:0 offset1:1
  ds_write_b32 v3, v166 offset:8
  v_add_u32 v3, 768, v3
  ds_write2_b32 v3, v168, v169 offset0:0 offset1:1
  ds_write_b32 v3, v170 offset:8
  v_add_u32 v3, 768, v3
  ds_write2_b32 v3, v172, v173 offset0:0 offset1:1
  ds_write_b32 v3, v174 offset:8
  v_add_u32 v3, 768, v3
  ds_write2_b32 v3, v176, v177 offset0:0 offset1:1
  ds_write_b32 v3, v178 offset:8
  v_add_u32 v3, 768, v3
  ds_write2_b32 v3, v180, v181 offset0:0 offset1:1
  ds_write_b32 v3, v182 offset:8
  v_add_u32 v3, 768, v3
  ds_write2_b32 v3, v184, v185 offset0:0 offset1:1
  ds_write_b32 v3, v186 offset:8
  v_add_u32 v3, 768, v3
  ds_write2_b32 v3, v188, v189 offset0:0 offset1:1
  ds_write_b32 v3, v190 offset:8
  v_add_u32 v3, 60160, v3
  ds_write2_b32 v3, v192, v193 offset0:0 offset1:1
  ds_write_b32 v3, v194 offset:8
  v_add_u32 v3, 768, v3
  ds_write2_b32 v3, v196, v197 offset0:0 offset1:1
  ds_write_b32 v3, v198 offset:8
  v_add_u32 v3, 768, v3
  ds_write2_b32 v3, v200, v201 offset0:0 offset1:1
  ds_write_b32 v3, v202 offset:8
  v_add_u32 v3, 768, v3
  ds_write2_b32 v3, v204, v205 offset0:0 offset1:1
  ds_write_b32 v3, v206 offset:8
  v_add_u32 v3, 768, v3
  ds_write2_b32 v3, v208, v209 offset0:0 offset1:1
  ds_write_b32 v3, v210 offset:8
  v_add_u32 v3, 768, v3
  ds_write2_b32 v3, v212, v213 offset0:0 offset1:1
  ds_write_b32 v3, v214 offset:8
  v_add_u32 v3, 768, v3
  ds_write2_b32 v3, v216, v217 offset0:0 offset1:1
  ds_write_b32 v3, v218 offset:8
  v_add_u32 v3, 768, v3
  ds_write2_b32 v3, v220, v221 offset0:0 offset1:1
  ds_write_b32 v3, v222 offset:8
  v_add_u32 v3, 768, v3
  v_mov_b32 v6, 0
  s_mov_b32 s19, 262144
L_cpc:
  s_sleep 8
  ds_read_b32 v7, v6 offset:24
  s_sub_u32 s19, s19, 1
  s_cbranch_scc1 L_exit
  s_waitcnt lgkmcnt(0)
  v_cmp_ne_u32 vcc, s6, v7
  s_cbranch_vccnz L_cpc
  ds_read_b32 v7, v6 offset:28
  s_waitcnt lgkmcnt(0)
  v_readfirstlane_b32 s48, v7
  s_nop 0
  s_and_b32 s18, s35, 1
  s_xor_b32 s18, s18, 1
  s_lshl_b32 s18, s18, 13
  s_xor_b32 s48, s48, s18
  s_lshl_b32 s18, s35, 11
  s_add_u32 s18, s18, s48
  s_add_u32 s18, s18, 1572864
  v_lshl_add_u32 v224, v1, 4, s18
  v_add_u32 v225, 16384, v224
  s_mov_b32 s51, 0x36000000
  s_mov_b32 s56, 0x42000000
  v_mov_b32 v168, 0
  v_mov_b32 v169, 0
  v_mov_b32 v170, 0
  v_mov_b32 v171, 0
  v_mov_b32 v172, 0
  v_mov_b32 v173, 0
  v_mov_b32 v174, 0
  v_mov_b32 v175, 0
  v_mov_b32 v6, 0
  s_mov_b32 s19, 262144
L_cd:
  s_sleep 1
  ds_read_b32 v7, v6 offset:16
  s_sub_u32 s19, s19, 1
  s_cbranch_scc1 L_exit
  s_waitcnt lgkmcnt(0)
  v_cmp_gt_u32 vcc, 5, v7
  s_cbranch_vccnz L_cd
  s_setprio 3
  s_mov_b32 s19, 262144
L_cp:
  global_load_dwordx4 v[20:23], v224, s[32:33] sc1
  global_load_dwordx4 v[24:27], v224, s[32:33] offset:1024 sc1
  global_load_dwordx4 v[176:179], v225, s[32:33] sc1
  global_load_dwordx4 v[180:183], v225, s[32:33] offset:1024 sc1
  s_sub_u32 s19, s19, 1
  s_cbranch_scc1 L_exit
  s_mov_b64 s[48:49], s[46:47]
  s_waitcnt vmcnt(2)
  v_cmp_eq_f32 vcc, v60, v23
  v_cmp_eq_f32 s[52:53], v61, v27
  s_and_b64 s[48:49], s[48:49], vcc
  s_and_b64 s[48:49], s[48:49], s[52:53]
  s_waitcnt vmcnt(0)
  v_cmp_eq_f32 vcc, v60, v179
  v_cmp_eq_f32 s[52:53], v61, v183
  v_pk_add_f32 v[20:21], v[20:21], v[176:177]
  v_pk_add_f32 v[22:23], v[22:23], v[178:179]
  v_pk_add_f32 v[24:25], v[24:25], v[180:181]
  v_pk_add_f32 v[26:27], v[26:27], v[182:183]
  s_and_b64 s[48:49], s[48:49], vcc
  s_and_b64 s[48:49], s[48:49], s[52:53]
  s_cmp_eq_u64 s[48:49], s[46:47]
  s_cbranch_scc0 L_cp
  v_cvt_pk_bf16_f32 v20, 0, v20
  v_cvt_pk_bf16_f32 v21, 0, v21
  v_cvt_pk_bf16_f32 v22, 0, v22
  v_cvt_pk_bf16_f32 v23, 0, v23
  v_cvt_pk_bf16_f32 v24, 0, v24
  v_cvt_pk_bf16_f32 v25, 0, v25
  v_cvt_pk_bf16_f32 v26, 0, v26
  v_cvt_pk_bf16_f32 v27, 0, v27
  v_pk_add_f32 v[20:21], v[20:21], v[12:13]
  v_pk_add_f32 v[22:23], v[22:23], v[14:15]
  v_pk_add_f32 v[24:25], v[24:25], v[16:17]
  v_pk_add_f32 v[26:27], v[26:27], v[18:19]
  v_cvt_pk_bf16_f32 v32, 0, v20
  v_cvt_pk_bf16_f32 v33, 0, v21
  v_cvt_pk_bf16_f32 v34, 0, v22
  v_cvt_pk_bf16_f32 v35, 0, v23
  v_cvt_pk_bf16_f32 v36, 0, v24
  v_cvt_pk_bf16_f32 v37, 0, v25
  v_cvt_pk_bf16_f32 v38, 0, v26
  v_cvt_pk_bf16_f32 v39, 0, v27
  v_readfirstlane_b32 s50, v32
  s_nop 1
  v_pk_add_f32 v[40:41], v[32:33], s[50:51] op_sel_hi:[1,0] neg_lo:[0,1] neg_hi:[0,1]
  v_pk_add_f32 v[42:43], v[34:35], s[50:51] op_sel_hi:[1,0] neg_lo:[0,1] neg_hi:[0,1]
  v_pk_add_f32 v[44:45], v[36:37], s[50:51] op_sel_hi:[1,0] neg_lo:[0,1] neg_hi:[0,1]
  v_pk_add_f32 v[46:47], v[38:39], s[50:51] op_sel_hi:[1,0] neg_lo:[0,1] neg_hi:[0,1]
  v_cndmask_b32 v42, v42, 0, s[46:47]
  v_cndmask_b32 v43, v43, 0, s[46:47]
  v_cndmask_b32 v46, v46, 0, s[46:47]
  v_cndmask_b32 v47, v47, 0, s[46:47]
  v_pk_add_f32 v[48:49], v[40:41], v[44:45]
  v_pk_mul_f32 v[50:51], v[40:41], v[40:41]
  v_pk_add_f32 v[48:49], v[48:49], v[42:43]
  v_pk_fma_f32 v[50:51], v[44:45], v[44:45], v[50:51]
  v_pk_add_f32 v[48:49], v[48:49], v[46:47]
  v_pk_fma_f32 v[50:51], v[42:43], v[42:43], v[50:51]
  v_add_f32 v48, v48, v49
  v_pk_fma_f32 v[50:51], v[46:47], v[46:47], v[50:51]
  v_add_f32 v50, v50, v51
  s_nop 0
  v_add_f32_dpp v48, v48, v48 row_ror:8 row_mask:0xf bank_mask:0xf
  v_add_f32_dpp v50, v50, v50 row_ror:8 row_mask:0xf bank_mask:0xf
  s_nop 0
  v_add_f32_dpp v48, v48, v48 row_ror:4 row_mask:0xf bank_mask:0xf
  v_add_f32_dpp v50, v50, v50 row_ror:4 row_mask:0xf bank_mask:0xf
  s_nop 0
  v_add_f32_dpp v48, v48, v48 row_ror:2 row_mask:0xf bank_mask:0xf
  v_add_f32_dpp v50, v50, v50 row_ror:2 row_mask:0xf bank_mask:0xf
  s_nop 0
  v_add_f32_dpp v48, v48, v48 row_ror:1 row_mask:0xf bank_mask:0xf
  v_add_f32_dpp v50, v50, v50 row_ror:1 row_mask:0xf bank_mask:0xf
  v_mov_b32 v49, v48
  v_mov_b32 v51, v50
  s_nop 0
  v_permlane16_swap_b32 v48, v49
  v_permlane16_swap_b32 v50, v51
  v_add_f32 v48, v48, v49
  v_add_f32 v50, v50, v51
  v_mov_b32 v49, v48
  v_mov_b32 v51, v50
  s_nop 0
  v_permlane32_swap_b32 v48, v49
  v_permlane32_swap_b32 v50, v51
  v_add_f32 v48, v48, v49
  v_add_f32 v50, v50, v51
  v_mul_f32 v48, s62, v48
  v_mul_f32 v58, v48, v48
  v_fma_f32 v50, v50, s62, -v58
  v_add_f32 v48, s50, v48
  v_max_f32 v50, 0, v50
  v_cvt_pk_bf16_f32 v59, 0, v50
  v_cvt_pk_bf16_f32 v54, 0, v48
  v_add_f32 v59, s63, v59
  v_cvt_pk_bf16_f32 v59, 0, v59
  v_sqrt_f32 v59, v59
  s_nop 0
  v_cvt_pk_bf16_f32 v59, 0, v59
  v_rcp_f32 v56, v59
  s_nop 0
  v_pk_add_f32 v[20:21], v[32:33], v[54:55] op_sel_hi:[1,0] neg_lo:[0,1] neg_hi:[0,1]
  v_pk_add_f32 v[22:23], v[34:35], v[54:55] op_sel_hi:[1,0] neg_lo:[0,1] neg_hi:[0,1]
  v_pk_add_f32 v[24:25], v[36:37], v[54:55] op_sel_hi:[1,0] neg_lo:[0,1] neg_hi:[0,1]
  v_pk_add_f32 v[26:27], v[38:39], v[54:55] op_sel_hi:[1,0] neg_lo:[0,1] neg_hi:[0,1]
  v_cvt_pk_bf16_f32 v20, 0, v20
  v_cvt_pk_bf16_f32 v21, 0, v21
  v_cvt_pk_bf16_f32 v22, 0, v22
  v_cvt_pk_bf16_f32 v23, 0, v23
  v_cvt_pk_bf16_f32 v24, 0, v24
  v_cvt_pk_bf16_f32 v25, 0, v25
  v_cvt_pk_bf16_f32 v26, 0, v26
  v_cvt_pk_bf16_f32 v27, 0, v27
  v_pk_mul_f32 v[20:21], v[20:21], v[56:57] op_sel_hi:[1,0]
  v_pk_mul_f32 v[22:23], v[22:23], v[56:57] op_sel_hi:[1,0]
  v_pk_mul_f32 v[24:25], v[24:25], v[56:57] op_sel_hi:[1,0]
  v_pk_mul_f32 v[26:27], v[26:27], v[56:57] op_sel_hi:[1,0]
  v_cvt_pk_bf16_f32 v20, 0, v20
  v_cvt_pk_bf16_f32 v21, 0, v21
  v_cvt_pk_bf16_f32 v22, 0, v22
  v_cvt_pk_bf16_f32 v23, 0, v23
  v_cvt_pk_bf16_f32 v24, 0, v24
  v_cvt_pk_bf16_f32 v25, 0, v25
  v_cvt_pk_bf16_f32 v26, 0, v26
  v_cvt_pk_bf16_f32 v27, 0, v27
  v_cndmask_b32 v42, v22, 0, s[46:47]
  v_cndmask_b32 v43, v23, 0, s[46:47]
  v_cndmask_b32 v46, v26, 0, s[46:47]
  v_cndmask_b32 v47, v27, 0, s[46:47]
  v_pk_add_f32 v[48:49], v[20:21], v[24:25]
  v_pk_mul_f32 v[50:51], v[20:21], v[20:21]
  v_pk_add_f32 v[48:49], v[48:49], v[42:43]
  v_pk_fma_f32 v[50:51], v[24:25], v[24:25], v[50:51]
  v_pk_add_f32 v[48:49], v[48:49], v[46:47]
  v_pk_fma_f32 v[50:51], v[42:43], v[42:43], v[50:51]
  v_add_f32 v48, v48, v49
  v_pk_fma_f32 v[50:51], v[46:47], v[46:47], v[50:51]
  v_add_f32 v50, v50, v51
  s_nop 0
  v_add_f32_dpp v48, v48, v48 row_ror:8 row_mask:0xf bank_mask:0xf
  v_add_f32_dpp v50, v50, v50 row_ror:8 row_mask:0xf bank_mask:0xf
  s_nop 0
  v_add_f32_dpp v48, v48, v48 row_ror:4 row_mask:0xf bank_mask:0xf
  v_add_f32_dpp v50, v50, v50 row_ror:4 row_mask:0xf bank_mask:0xf
  s_nop 0
  v_add_f32_dpp v48, v48, v48 row_ror:2 row_mask:0xf bank_mask:0xf
  v_add_f32_dpp v50, v50, v50 row_ror:2 row_mask:0xf bank_mask:0xf
  s_nop 0
  v_add_f32_dpp v48, v48, v48 row_ror:1 row_mask:0xf bank_mask:0xf
  v_add_f32_dpp v50, v50, v50 row_ror:1 row_mask:0xf bank_mask:0xf
  v_mov_b32 v49, v48
  v_mov_b32 v51, v50
  s_nop 0
  v_permlane16_swap_b32 v48, v49
  v_permlane16_swap_b32 v50, v51
  v_add_f32 v48, v48, v49
  v_add_f32 v50, v50, v51
  v_mov_b32 v49, v48
  v_mov_b32 v51, v50
  s_nop 0
  v_permlane32_swap_b32 v48, v49
  v_permlane32_swap_b32 v50, v51
  v_add_f32 v48, v48, v49
  v_add_f32 v50, v50, v51
  v_mul_f32 v48, s62, v48
  v_mul_f32 v58, v48, v48
  v_fma_f32 v50, v50, s62, -v58
  v_max_f32 v50, 0, v50
  v_cvt_pk_bf16_f32 v59, 0, v50
  v_cvt_pk_bf16_f32 v54, 0, v48
  v_add_f32 v59, s63, v59
  v_cvt_pk_bf16_f32 v59, 0, v59
  v_sqrt_f32 v59, v59
  s_nop 0
  v_cvt_pk_bf16_f32 v59, 0, v59
  v_rcp_f32 v56, v59
  s_nop 0
  v_pk_add_f32 v[20:21], v[20:21], v[54:55] op_sel_hi:[1,0] neg_lo:[0,1] neg_hi:[0,1]
  v_pk_add_f32 v[22:23], v[22:23], v[54:55] op_sel_hi:[1,0] neg_lo:[0,1] neg_hi:[0,1]
  v_pk_add_f32 v[24:25], v[24:25], v[54:55] op_sel_hi:[1,0] neg_lo:[0,1] neg_hi:[0,1]
  v_pk_add_f32 v[26:27], v[26:27], v[54:55] op_sel_hi:[1,0] neg_lo:[0,1] neg_hi:[0,1]
  v_cvt_pk_bf16_f32 v20, 0, v20
  v_cvt_pk_bf16_f32 v21, 0, v21
  v_cvt_pk_bf16_f32 v22, 0, v22
  v_cvt_pk_bf16_f32 v23, 0, v23
  v_cvt_pk_bf16_f32 v24, 0, v24
  v_cvt_pk_bf16_f32 v25, 0, v25
  v_cvt_pk_bf16_f32 v26, 0, v26
  v_cvt_pk_bf16_f32 v27, 0, v27
  v_pk_mul_f32 v[20:21], v[20:21], v[56:57] op_sel_hi:[1,0]
  v_pk_mul_f32 v[22:23], v[22:23], v[56:57] op_sel_hi:[1,0]
  v_pk_mul_f32 v[24:25], v[24:25], v[56:57] op_sel_hi:[1,0]
  v_pk_mul_f32 v[26:27], v[26:27], v[56:57] op_sel_hi:[1,0]
  v_cvt_pk_bf16_f32 v20, 0, v20
  v_cvt_pk_bf16_f32 v21, 0, v21
  v_cvt_pk_bf16_f32 v22, 0, v22
  v_cvt_pk_bf16_f32 v23, 0, v23
  v_cvt_pk_bf16_f32 v24, 0, v24
  v_cvt_pk_bf16_f32 v25, 0, v25
  v_cvt_pk_bf16_f32 v26, 0, v26
  v_cvt_pk_bf16_f32 v27, 0, v27
  v_lshrrev_b32 v40, 15, v20
  v_lshrrev_b32 v41, 15, v21
  v_lshrrev_b32 v42, 15, v22
  v_lshrrev_b32 v43, 15, v23
  v_lshrrev_b32 v44, 15, v24
  v_lshrrev_b32 v45, 15, v25
  v_lshrrev_b32 v46, 15, v26
  v_lshrrev_b32 v47, 15, v27
  ds_read_u16_d16_hi v168, v40
  ds_read_u16_d16_hi v169, v41
  ds_read_u16_d16_hi v170, v42
  ds_read_u16_d16_hi v171, v43
  ds_read_u16_d16_hi v172, v44
  ds_read_u16_d16_hi v173, v45
  ds_read_u16_d16_hi v174, v46
  ds_read_u16_d16_hi v175, v47
  v_cndmask_b32 v22, v22, 1.0, s[46:47]
  v_cndmask_b32 v23, v23, 1.0, s[46:47]
  v_cndmask_b32 v26, v26, 1.0, s[46:47]
  v_cndmask_b32 v27, v27, 1.0, s[46:47]
  v_min3_f32 v48, |v20|, |v21|, |v22|
  v_max3_f32 v49, |v20|, |v21|, |v22|
  v_min3_f32 v48, v48, |v23|, |v24|
  v_max3_f32 v49, v49, |v23|, |v24|
  v_min3_f32 v48, v48, |v25|, |v26|
  v_max3_f32 v49, v49, |v25|, |v26|
  v_min_f32 v48, v48, |v27|
  v_max_f32 v49, v49, |v27|
  v_mul_f32 v50, v56, v54
  v_cmp_gt_f32 vcc, s51, v48
  v_cmp_le_f32 s[52:53], s56, v49
  v_cmp_u_f32 s[54:55], v50, v50
  s_or_b64 vcc, vcc, s[52:53]
  s_or_b64 vcc, vcc, s[54:55]
  s_waitcnt lgkmcnt(0)
  s_cbranch_vccnz L_cslow
L_cfin:
  v_pk_add_f32 v[168:169], v[168:169], v[32:33]
  v_pk_add_f32 v[170:171], v[170:171], v[34:35]
  v_pk_add_f32 v[172:173], v[172:173], v[36:37]
  v_pk_add_f32 v[174:175], v[174:175], v[38:39]
  v_cvt_pk_bf16_f32 v28, v168, v169
  v_cvt_pk_bf16_f32 v29, v170, v171
  v_cvt_pk_bf16_f32 v30, v172, v173
  v_cvt_pk_bf16_f32 v31, v174, v175
  buffer_store_dword v28, v2, s[40:43], s44 offen
  buffer_store_dword v30, v2, s[40:43], s44 offen offset:448
  s_andn2_b64 exec, exec, s[46:47]
  buffer_store_dword v29, v2, s[40:43], s44 offen offset:4
  buffer_store_dword v31, v2, s[40:43], s44 offen offset:452
  s_endpgm
L_cslow:
  s_mov_b32 s57, 0x36000000
  s_mov_b32 s58, 0xc000000
  v_and_b32 v48, 0x7fffffff, v20
  v_subrev_u32 v48, s57, v48
  v_cmp_le_u32 s[52:53], s58, v48
L_cs6:
  s_cmp_eq_u64 s[52:53], 0
  s_cbranch_scc1 L_ce6
  s_ff1_i32_b64 s54, s[52:53]
  s_bitset0_b64 s[52:53], s54
  v_readlane_b32 s70, v20, s54
  s_nop 0
  s_mov_b32 s71, s70
  s_nop 0
  s_call_b64 s[76:77], L_eval
  s_nop 0
  v_readfirstlane_b32 s55, v153
  s_mov_b32 m0, s54
  s_lshl_b32 s55, s55, 16
  s_nop 3
  v_writelane_b32 v168, s55, m0
  s_branch L_cs6
L_ce6:
  v_and_b32 v48, 0x7fffffff, v21
  v_subrev_u32 v48, s57, v48
  v_cmp_le_u32 s[52:53], s58, v48
L_cs7:
  s_cmp_eq_u64 s[52:53], 0
  s_cbranch_scc1 L_ce7
  s_ff1_i32_b64 s54, s[52:53]
  s_bitset0_b64 s[52:53], s54
  v_readlane_b32 s70, v21, s54
  s_nop 0
  s_mov_b32 s71, s70
  s_nop 0
  s_call_b64 s[76:77], L_eval
  s_nop 0
  v_readfirstlane_b32 s55, v153
  s_mov_b32 m0, s54
  s_lshl_b32 s55, s55, 16
  s_nop 3
  v_writelane_b32 v169, s55, m0
  s_branch L_cs7
L_ce7:
  v_and_b32 v48, 0x7fffffff, v22
  v_subrev_u32 v48, s57, v48
  v_cmp_le_u32 s[52:53], s58, v48
L_cs8:
  s_cmp_eq_u64 s[52:53], 0
  s_cbranch_scc1 L_ce8
  s_ff1_i32_b64 s54, s[52:53]
  s_bitset0_b64 s[52:53], s54
  v_readlane_b32 s70, v22, s54
  s_nop 0
  s_mov_b32 s71, s70
  s_nop 0
  s_call_b64 s[76:77], L_eval
  s_nop 0
  v_readfirstlane_b32 s55, v153
  s_mov_b32 m0, s54
  s_lshl_b32 s55, s55, 16
  s_nop 3
  v_writelane_b32 v170, s55, m0
  s_branch L_cs8
L_ce8:
  v_and_b32 v48, 0x7fffffff, v23
  v_subrev_u32 v48, s57, v48
  v_cmp_le_u32 s[52:53], s58, v48
L_cs9:
  s_cmp_eq_u64 s[52:53], 0
  s_cbranch_scc1 L_ce9
  s_ff1_i32_b64 s54, s[52:53]
  s_bitset0_b64 s[52:53], s54
  v_readlane_b32 s70, v23, s54
  s_nop 0
  s_mov_b32 s71, s70
  s_nop 0
  s_call_b64 s[76:77], L_eval
  s_nop 0
  v_readfirstlane_b32 s55, v153
  s_mov_b32 m0, s54
  s_lshl_b32 s55, s55, 16
  s_nop 3
  v_writelane_b32 v171, s55, m0
  s_branch L_cs9
L_ce9:
  v_and_b32 v48, 0x7fffffff, v24
  v_subrev_u32 v48, s57, v48
  v_cmp_le_u32 s[52:53], s58, v48
L_cs10:
  s_cmp_eq_u64 s[52:53], 0
  s_cbranch_scc1 L_ce10
  s_ff1_i32_b64 s54, s[52:53]
  s_bitset0_b64 s[52:53], s54
  v_readlane_b32 s70, v24, s54
  s_nop 0
  s_mov_b32 s71, s70
  s_nop 0
  s_call_b64 s[76:77], L_eval
  s_nop 0
  v_readfirstlane_b32 s55, v153
  s_mov_b32 m0, s54
  s_lshl_b32 s55, s55, 16
  s_nop 3
  v_writelane_b32 v172, s55, m0
  s_branch L_cs10
L_ce10:
  v_and_b32 v48, 0x7fffffff, v25
  v_subrev_u32 v48, s57, v48
  v_cmp_le_u32 s[52:53], s58, v48
L_cs11:
  s_cmp_eq_u64 s[52:53], 0
  s_cbranch_scc1 L_ce11
  s_ff1_i32_b64 s54, s[52:53]
  s_bitset0_b64 s[52:53], s54
  v_readlane_b32 s70, v25, s54
  s_nop 0
  s_mov_b32 s71, s70
  s_nop 0
  s_call_b64 s[76:77], L_eval
  s_nop 0
  v_readfirstlane_b32 s55, v153
  s_mov_b32 m0, s54
  s_lshl_b32 s55, s55, 16
  s_nop 3
  v_writelane_b32 v173, s55, m0
  s_branch L_cs11
L_ce11:
  v_and_b32 v48, 0x7fffffff, v26
  v_subrev_u32 v48, s57, v48
  v_cmp_le_u32 s[52:53], s58, v48
L_cs12:
  s_cmp_eq_u64 s[52:53], 0
  s_cbranch_scc1 L_ce12
  s_ff1_i32_b64 s54, s[52:53]
  s_bitset0_b64 s[52:53], s54
  v_readlane_b32 s70, v26, s54
  s_nop 0
  s_mov_b32 s71, s70
  s_nop 0
  s_call_b64 s[76:77], L_eval
  s_nop 0
  v_readfirstlane_b32 s55, v153
  s_mov_b32 m0, s54
  s_lshl_b32 s55, s55, 16
  s_nop 3
  v_writelane_b32 v174, s55, m0
  s_branch L_cs12
L_ce12:
  v_and_b32 v48, 0x7fffffff, v27
  v_subrev_u32 v48, s57, v48
  v_cmp_le_u32 s[52:53], s58, v48
L_cs13:
  s_cmp_eq_u64 s[52:53], 0
  s_cbranch_scc1 L_ce13
  s_ff1_i32_b64 s54, s[52:53]
  s_bitset0_b64 s[52:53], s54
  v_readlane_b32 s70, v27, s54
  s_nop 0
  s_mov_b32 s71, s70
  s_nop 0
  s_call_b64 s[76:77], L_eval
  s_nop 0
  v_readfirstlane_b32 s55, v153
  s_mov_b32 m0, s54
  s_lshl_b32 s55, s55, 16
  s_nop 3
  v_writelane_b32 v175, s55, m0
  s_branch L_cs13
L_ce13:
  s_branch L_cfin
L_eval:
  v_mov_b32 v152, 0
  v_pk_mul_f32 v[136:137], v[64:65], s[70:71]
  v_pk_mul_f32 v[142:143], v[66:67], s[70:71]
  v_cvt_pk_bf16_f32 v136, 0, v136
  v_cvt_pk_bf16_f32 v137, 0, v137
  v_cvt_pk_bf16_f32 v142, 0, v142
  v_cvt_pk_bf16_f32 v143, 0, v143
  v_pk_add_f32 v[136:137], v[136:137], v[92:93]
  v_pk_add_f32 v[142:143], v[142:143], v[94:95]
  v_cvt_pk_bf16_f32 v136, 0, v136
  v_cvt_pk_bf16_f32 v137, 0, v137
  v_cvt_pk_bf16_f32 v142, 0, v142
  v_cvt_pk_bf16_f32 v143, 0, v143
  v_pk_mul_f32 v[138:139], v[136:137], v[136:137]
  v_pk_mul_f32 v[144:145], v[142:143], v[142:143]
  v_pk_fma_f32 v[138:139], v[138:139], s[72:73], v[134:135]
  v_pk_fma_f32 v[144:145], v[144:145], s[72:73], v[134:135]
  v_pk_mul_f32 v[138:139], v[138:139], v[136:137]
  v_pk_mul_f32 v[144:145], v[144:145], v[142:143]
  v_exp_f32 v138, v138
  v_exp_f32 v139, v139
  v_exp_f32 v144, v144
  v_exp_f32 v145, v145
  s_nop 0
  v_add_f32 v138, 1.0, v138
  v_add_f32 v139, 1.0, v139
  v_add_f32 v144, 1.0, v144
  v_add_f32 v145, 1.0, v145
  v_rcp_f32 v138, v138
  v_rcp_f32 v139, v139
  v_rcp_f32 v144, v144
  v_rcp_f32 v145, v145
  s_nop 0
  v_pk_mul_f32 v[136:137], v[136:137], v[138:139]
  v_pk_mul_f32 v[142:143], v[142:143], v[144:145]
  v_cvt_pk_bf16_f32 v140, v136, v137
  v_cvt_pk_bf16_f32 v146, v142, v143
  v_dot2c_f32_bf16 v152, v140, v120
  v_dot2c_f32_bf16 v152, v146, v121
  v_pk_mul_f32 v[136:137], v[68:69], s[70:71]
  v_pk_mul_f32 v[142:143], v[70:71], s[70:71]
  v_cvt_pk_bf16_f32 v136, 0, v136
  v_cvt_pk_bf16_f32 v137, 0, v137
  v_cvt_pk_bf16_f32 v142, 0, v142
  v_cvt_pk_bf16_f32 v143, 0, v143
  v_pk_add_f32 v[136:137], v[136:137], v[96:97]
  v_pk_add_f32 v[142:143], v[142:143], v[98:99]
  v_cvt_pk_bf16_f32 v136, 0, v136
  v_cvt_pk_bf16_f32 v137, 0, v137
  v_cvt_pk_bf16_f32 v142, 0, v142
  v_cvt_pk_bf16_f32 v143, 0, v143
  v_pk_mul_f32 v[138:139], v[136:137], v[136:137]
  v_pk_mul_f32 v[144:145], v[142:143], v[142:143]
  v_pk_fma_f32 v[138:139], v[138:139], s[72:73], v[134:135]
  v_pk_fma_f32 v[144:145], v[144:145], s[72:73], v[134:135]
  v_pk_mul_f32 v[138:139], v[138:139], v[136:137]
  v_pk_mul_f32 v[144:145], v[144:145], v[142:143]
  v_exp_f32 v138, v138
  v_exp_f32 v139, v139
  v_exp_f32 v144, v144
  v_exp_f32 v145, v145
  s_nop 0
  v_add_f32 v138, 1.0, v138
  v_add_f32 v139, 1.0, v139
  v_add_f32 v144, 1.0, v144
  v_add_f32 v145, 1.0, v145
  v_rcp_f32 v138, v138
  v_rcp_f32 v139, v139
  v_rcp_f32 v144, v144
  v_rcp_f32 v145, v145
  s_nop 0
  v_pk_mul_f32 v[136:137], v[136:137], v[138:139]
  v_pk_mul_f32 v[142:143], v[142:143], v[144:145]
  v_cvt_pk_bf16_f32 v140, v136, v137
  v_cvt_pk_bf16_f32 v146, v142, v143
  v_dot2c_f32_bf16 v152, v140, v122
  v_dot2c_f32_bf16 v152, v146, v123
  v_pk_mul_f32 v[136:137], v[72:73], s[70:71]
  v_pk_mul_f32 v[142:143], v[74:75], s[70:71]
  v_cvt_pk_bf16_f32 v136, 0, v136
  v_cvt_pk_bf16_f32 v137, 0, v137
  v_cvt_pk_bf16_f32 v142, 0, v142
  v_cvt_pk_bf16_f32 v143, 0, v143
  v_pk_add_f32 v[136:137], v[136:137], v[100:101]
  v_pk_add_f32 v[142:143], v[142:143], v[102:103]
  v_cvt_pk_bf16_f32 v136, 0, v136
  v_cvt_pk_bf16_f32 v137, 0, v137
  v_cvt_pk_bf16_f32 v142, 0, v142
  v_cvt_pk_bf16_f32 v143, 0, v143
  v_pk_mul_f32 v[138:139], v[136:137], v[136:137]
  v_pk_mul_f32 v[144:145], v[142:143], v[142:143]
  v_pk_fma_f32 v[138:139], v[138:139], s[72:73], v[134:135]
  v_pk_fma_f32 v[144:145], v[144:145], s[72:73], v[134:135]
  v_pk_mul_f32 v[138:139], v[138:139], v[136:137]
  v_pk_mul_f32 v[144:145], v[144:145], v[142:143]
  v_exp_f32 v138, v138
  v_exp_f32 v139, v139
  v_exp_f32 v144, v144
  v_exp_f32 v145, v145
  s_nop 0
  v_add_f32 v138, 1.0, v138
  v_add_f32 v139, 1.0, v139
  v_add_f32 v144, 1.0, v144
  v_add_f32 v145, 1.0, v145
  v_rcp_f32 v138, v138
  v_rcp_f32 v139, v139
  v_rcp_f32 v144, v144
  v_rcp_f32 v145, v145
  s_nop 0
  v_pk_mul_f32 v[136:137], v[136:137], v[138:139]
  v_pk_mul_f32 v[142:143], v[142:143], v[144:145]
  v_cvt_pk_bf16_f32 v140, v136, v137
  v_cvt_pk_bf16_f32 v146, v142, v143
  v_dot2c_f32_bf16 v152, v140, v124
  v_dot2c_f32_bf16 v152, v146, v125
  v_pk_mul_f32 v[136:137], v[76:77], s[70:71]
  v_pk_mul_f32 v[142:143], v[78:79], s[70:71]
  v_cvt_pk_bf16_f32 v136, 0, v136
  v_cvt_pk_bf16_f32 v137, 0, v137
  v_cvt_pk_bf16_f32 v142, 0, v142
  v_cvt_pk_bf16_f32 v143, 0, v143
  v_pk_add_f32 v[136:137], v[136:137], v[104:105]
  v_pk_add_f32 v[142:143], v[142:143], v[106:107]
  v_cvt_pk_bf16_f32 v136, 0, v136
  v_cvt_pk_bf16_f32 v137, 0, v137
  v_cvt_pk_bf16_f32 v142, 0, v142
  v_cvt_pk_bf16_f32 v143, 0, v143
  v_pk_mul_f32 v[138:139], v[136:137], v[136:137]
  v_pk_mul_f32 v[144:145], v[142:143], v[142:143]
  v_pk_fma_f32 v[138:139], v[138:139], s[72:73], v[134:135]
  v_pk_fma_f32 v[144:145], v[144:145], s[72:73], v[134:135]
  v_pk_mul_f32 v[138:139], v[138:139], v[136:137]
  v_pk_mul_f32 v[144:145], v[144:145], v[142:143]
  v_exp_f32 v138, v138
  v_exp_f32 v139, v139
  v_exp_f32 v144, v144
  v_exp_f32 v145, v145
  s_nop 0
  v_add_f32 v138, 1.0, v138
  v_add_f32 v139, 1.0, v139
  v_add_f32 v144, 1.0, v144
  v_add_f32 v145, 1.0, v145
  v_rcp_f32 v138, v138
  v_rcp_f32 v139, v139
  v_rcp_f32 v144, v144
  v_rcp_f32 v145, v145
  s_nop 0
  v_pk_mul_f32 v[136:137], v[136:137], v[138:139]
  v_pk_mul_f32 v[142:143], v[142:143], v[144:145]
  v_cvt_pk_bf16_f32 v140, v136, v137
  v_cvt_pk_bf16_f32 v146, v142, v143
  v_dot2c_f32_bf16 v152, v140, v126
  v_dot2c_f32_bf16 v152, v146, v127
  v_pk_mul_f32 v[136:137], v[80:81], s[70:71]
  v_pk_mul_f32 v[142:143], v[82:83], s[70:71]
  v_cvt_pk_bf16_f32 v136, 0, v136
  v_cvt_pk_bf16_f32 v137, 0, v137
  v_cvt_pk_bf16_f32 v142, 0, v142
  v_cvt_pk_bf16_f32 v143, 0, v143
  v_pk_add_f32 v[136:137], v[136:137], v[108:109]
  v_pk_add_f32 v[142:143], v[142:143], v[110:111]
  v_cvt_pk_bf16_f32 v136, 0, v136
  v_cvt_pk_bf16_f32 v137, 0, v137
  v_cvt_pk_bf16_f32 v142, 0, v142
  v_cvt_pk_bf16_f32 v143, 0, v143
  v_pk_mul_f32 v[138:139], v[136:137], v[136:137]
  v_pk_mul_f32 v[144:145], v[142:143], v[142:143]
  v_pk_fma_f32 v[138:139], v[138:139], s[72:73], v[134:135]
  v_pk_fma_f32 v[144:145], v[144:145], s[72:73], v[134:135]
  v_pk_mul_f32 v[138:139], v[138:139], v[136:137]
  v_pk_mul_f32 v[144:145], v[144:145], v[142:143]
  v_exp_f32 v138, v138
  v_exp_f32 v139, v139
  v_exp_f32 v144, v144
  v_exp_f32 v145, v145
  s_nop 0
  v_add_f32 v138, 1.0, v138
  v_add_f32 v139, 1.0, v139
  v_add_f32 v144, 1.0, v144
  v_add_f32 v145, 1.0, v145
  v_rcp_f32 v138, v138
  v_rcp_f32 v139, v139
  v_rcp_f32 v144, v144
  v_rcp_f32 v145, v145
  s_nop 0
  v_pk_mul_f32 v[136:137], v[136:137], v[138:139]
  v_pk_mul_f32 v[142:143], v[142:143], v[144:145]
  v_cvt_pk_bf16_f32 v140, v136, v137
  v_cvt_pk_bf16_f32 v146, v142, v143
  v_dot2c_f32_bf16 v152, v140, v128
  v_dot2c_f32_bf16 v152, v146, v129
  v_pk_mul_f32 v[136:137], v[84:85], s[70:71]
  v_pk_mul_f32 v[142:143], v[86:87], s[70:71]
  v_cvt_pk_bf16_f32 v136, 0, v136
  v_cvt_pk_bf16_f32 v137, 0, v137
  v_cvt_pk_bf16_f32 v142, 0, v142
  v_cvt_pk_bf16_f32 v143, 0, v143
  v_pk_add_f32 v[136:137], v[136:137], v[112:113]
  v_pk_add_f32 v[142:143], v[142:143], v[114:115]
  v_cvt_pk_bf16_f32 v136, 0, v136
  v_cvt_pk_bf16_f32 v137, 0, v137
  v_cvt_pk_bf16_f32 v142, 0, v142
  v_cvt_pk_bf16_f32 v143, 0, v143
  v_pk_mul_f32 v[138:139], v[136:137], v[136:137]
  v_pk_mul_f32 v[144:145], v[142:143], v[142:143]
  v_pk_fma_f32 v[138:139], v[138:139], s[72:73], v[134:135]
  v_pk_fma_f32 v[144:145], v[144:145], s[72:73], v[134:135]
  v_pk_mul_f32 v[138:139], v[138:139], v[136:137]
  v_pk_mul_f32 v[144:145], v[144:145], v[142:143]
  v_exp_f32 v138, v138
  v_exp_f32 v139, v139
  v_exp_f32 v144, v144
  v_exp_f32 v145, v145
  s_nop 0
  v_add_f32 v138, 1.0, v138
  v_add_f32 v139, 1.0, v139
  v_add_f32 v144, 1.0, v144
  v_add_f32 v145, 1.0, v145
  v_rcp_f32 v138, v138
  v_rcp_f32 v139, v139
  v_rcp_f32 v144, v144
  v_rcp_f32 v145, v145
  s_nop 0
  v_pk_mul_f32 v[136:137], v[136:137], v[138:139]
  v_pk_mul_f32 v[142:143], v[142:143], v[144:145]
  v_cvt_pk_bf16_f32 v140, v136, v137
  v_cvt_pk_bf16_f32 v146, v142, v143
  v_dot2c_f32_bf16 v152, v140, v130
  v_dot2c_f32_bf16 v152, v146, v131
  v_pk_mul_f32 v[136:137], v[88:89], s[70:71]
  v_pk_mul_f32 v[142:143], v[90:91], s[70:71]
  v_cvt_pk_bf16_f32 v136, 0, v136
  v_cvt_pk_bf16_f32 v137, 0, v137
  v_cvt_pk_bf16_f32 v142, 0, v142
  v_cvt_pk_bf16_f32 v143, 0, v143
  v_pk_add_f32 v[136:137], v[136:137], v[116:117]
  v_pk_add_f32 v[142:143], v[142:143], v[118:119]
  v_cvt_pk_bf16_f32 v136, 0, v136
  v_cvt_pk_bf16_f32 v137, 0, v137
  v_cvt_pk_bf16_f32 v142, 0, v142
  v_cvt_pk_bf16_f32 v143, 0, v143
  v_pk_mul_f32 v[138:139], v[136:137], v[136:137]
  v_pk_mul_f32 v[144:145], v[142:143], v[142:143]
  v_pk_fma_f32 v[138:139], v[138:139], s[72:73], v[134:135]
  v_pk_fma_f32 v[144:145], v[144:145], s[72:73], v[134:135]
  v_pk_mul_f32 v[138:139], v[138:139], v[136:137]
  v_pk_mul_f32 v[144:145], v[144:145], v[142:143]
  v_exp_f32 v138, v138
  v_exp_f32 v139, v139
  v_exp_f32 v144, v144
  v_exp_f32 v145, v145
  s_nop 0
  v_add_f32 v138, 1.0, v138
  v_add_f32 v139, 1.0, v139
  v_add_f32 v144, 1.0, v144
  v_add_f32 v145, 1.0, v145
  v_rcp_f32 v138, v138
  v_rcp_f32 v139, v139
  v_rcp_f32 v144, v144
  v_rcp_f32 v145, v145
  s_nop 0
  v_pk_mul_f32 v[136:137], v[136:137], v[138:139]
  v_pk_mul_f32 v[142:143], v[142:143], v[144:145]
  v_cvt_pk_bf16_f32 v140, v136, v137
  v_cvt_pk_bf16_f32 v146, v142, v143
  v_dot2c_f32_bf16 v152, v140, v132
  v_dot2c_f32_bf16 v152, v146, v133
  s_nop 1
  s_nop 1
  v_add_f32_dpp v152, v152, v152 row_ror:8 row_mask:0xf bank_mask:0xf
  s_nop 1
  v_add_f32_dpp v152, v152, v152 row_ror:4 row_mask:0xf bank_mask:0xf
  s_nop 1
  v_add_f32_dpp v152, v152, v152 row_ror:2 row_mask:0xf bank_mask:0xf
  s_nop 1
  v_add_f32_dpp v152, v152, v152 row_ror:1 row_mask:0xf bank_mask:0xf
  v_mov_b32 v136, v152
  s_nop 1
  v_permlane16_swap_b32 v152, v136
  v_add_f32 v152, v152, v136
  v_mov_b32 v136, v152
  s_nop 1
  v_permlane32_swap_b32 v152, v136
  v_add_f32 v152, v152, v136
  v_cvt_pk_bf16_f32 v152, 0, v152
  v_add_f32 v152, s74, v152
  v_cvt_pk_bf16_f32 v153, v152, 0
  s_setpc_b64 s[76:77]
L_exit:
  s_endpgm
.section .rodata,"a"
.p2align 6
.amdhsa_kernel sequential_preLN__mha_block_cached__mixer_token_mlp__decode_kernel
  .amdhsa_next_free_vgpr 256
  .amdhsa_next_free_sgpr 102
  .amdhsa_accum_offset 256
  .amdhsa_group_segment_fixed_size 0
  .amdhsa_kernarg_size 104
  .amdhsa_user_sgpr_count 2
  .amdhsa_user_sgpr_kernarg_segment_ptr 1
  .amdhsa_system_sgpr_workgroup_id_x 1
.end_amdhsa_kernel
```
